```python
import torch

def _softmax(x, axis=-1):
    return torch.softmax(x, dim=axis)

def _gelu(x):
    return torch.nn.functional.gelu(x, approximate='tanh')

def _silu(x):
    return torch.nn.functional.silu(x)

def _sigmoid(x):
    return torch.sigmoid(x)

def _layernorm(x, axis=-1, eps=1e-05):
    m = x.mean(dim=axis, keepdim=True)
    v = x.var(dim=axis, keepdim=True, unbiased=False)
    return (x - m) / torch.sqrt(v + eps)

def _scatter_add(tgt, idx, src, axis=0):
    return tgt.clone().index_add_(axis, idx, src)

def _segment_sum(src, seg, n):
    out = torch.zeros((n,) + src.shape[1:], dtype=src.dtype)
    return out.index_add_(0, seg, src)

def _pad(x, pw):
    flat = tuple((v for pair in reversed(pw) for v in pair))
    return torch.nn.functional.pad(x, flat)
kernel_name = 'standalone__kv_cache_quant_pre_rope_vs_post_rope__prompt'

def setup_inputs():

    _w = lambda a: (lambda t: t.to(torch.bfloat16) if t.is_floating_point() else t)(torch.as_tensor(a))
    B, Sq, Skv = (1, 2048, 2048)
    H, Dh0 = (8, 128)
    G = 64 if 64 > 0 else Dh0
    G = max(2, G // 2 * 2)
    Dh = max(G, Dh0 // G * G)
    Skv = max(Skv, Sq)
    ng = Dh // G
    bits = 3 if 3 > 1 else 4
    bits = max(2, min(8, bits))
    qmax = (1 << bits) - 1
    half = Dh // 2
    inv = 1.0 / 10000.0 ** (torch.arange(half) / max(1, half))
    ang_k = torch.arange(Skv)[:, None] * inv[None, :]
    ang_q = torch.arange(Skv - Sq, Skv)[:, None] * inv[None, :]
    kc = torch.cat([torch.cos(ang_k), torch.cos(ang_k)], dim=-1)
    ks = torch.cat([torch.sin(ang_k), torch.sin(ang_k)], dim=-1)
    qc = torch.cat([torch.cos(ang_q), torch.cos(ang_q)], dim=-1)
    qs = torch.cat([torch.sin(ang_q), torch.sin(ang_q)], dim=-1)
    qk_i = torch.randint(0, qmax + 1, (B, H, Skv, Dh)).to(torch.int32)
    qv_i = torch.randint(0, qmax + 1, (B, H, Skv, Dh)).to(torch.int32)
    ksc = torch.abs((lambda *s: torch.randn(*s, dtype=torch.bfloat16) * 0.4)(B, H, Skv, ng)) * 0.1 + 0.01
    kzp = torch.full((B, H, Skv, ng), qmax / 2.0)
    vsc = torch.abs((lambda *s: torch.randn(*s, dtype=torch.bfloat16) * 0.4)(B, H, Skv, ng)) * 0.1 + 0.01
    vzp = torch.full((B, H, Skv, ng), qmax / 2.0)
    return {'q': _w((lambda *s: torch.randn(*s, dtype=torch.bfloat16) * 6.4)(B, H, Sq, Dh) * 0.5), 'qk': _w(qk_i), 'k_scales': _w(ksc), 'k_zeros': _w(kzp), 'qv': _w(qv_i), 'v_scales': _w(vsc), 'v_zeros': _w(vzp), 'q_cos': _w(qc), 'q_sin': _w(qs), 'k_cos': _w(kc), 'k_sin': _w(ks)}

def reference(q, qk, k_scales, k_zeros, qv, v_scales, v_zeros, q_cos, q_sin, k_cos, k_sin):
    B, H, Sq, Dh = q.shape
    ng = k_scales.shape[-1]
    G = Dh // ng
    half = Dh // 2
    ks = (lambda x, n, axis: torch.repeat_interleave(x, n, dim=axis))(k_scales, G, axis=-1)
    kz = (lambda x, n, axis: torch.repeat_interleave(x, n, dim=axis))(k_zeros, G, axis=-1)
    k = ((lambda x, dt: x.to(dt))(qk, q.dtype) - kz) * ks
    vs = (lambda x, n, axis: torch.repeat_interleave(x, n, dim=axis))(v_scales, G, axis=-1)
    vz = (lambda x, n, axis: torch.repeat_interleave(x, n, dim=axis))(v_zeros, G, axis=-1)
    v = ((lambda x, dt: x.to(dt))(qv, q.dtype) - vz) * vs
    k1 = k[..., :half].clone()
    k2 = k[..., half:].clone()
    krh = torch.concatenate([-k2, k1], axis=-1)
    kr = k * k_cos[None, None, :, :] + krh * k_sin[None, None, :, :]
    q1 = q[..., :half].clone()
    q2 = q[..., half:].clone()
    qrh = torch.concatenate([-q2, q1], axis=-1)
    qr = q * q_cos[None, None, :, :] + qrh * q_sin[None, None, :, :]
    logits = torch.einsum('bhqd,bhkd->bhqk', qr, kr) * float(Dh) ** (-0.5)
    attn = _softmax(logits, axis=-1)
    out = torch.einsum('bhqk,bhkd->bhqd', attn, v)
    return out
```

```asm
; @launch grid=(256,1,1) block=(256,1,1) lds=156160
.amdgcn_target "amdgcn-amd-amdhsa--gfx950"
.text
.globl standalone__kv_cache_quant_pre_rope_vs_post_rope__prompt_kernel
.p2align 8
.type standalone__kv_cache_quant_pre_rope_vs_post_rope__prompt_kernel,@function
standalone__kv_cache_quant_pre_rope_vs_post_rope__prompt_kernel:
    s_cmp_ge_u32 s2, 256
    s_cbranch_scc1 M_end
    s_load_dwordx16 s[16:31], s[0:1], 0
    s_load_dwordx8 s[32:39], s[0:1], 64
    s_load_dwordx4 s[40:43], s[0:1], 96
    s_and_b32 s4, s2, 7
    s_lshr_b32 s5, s2, 3
    v_lshrrev_b32 v1, 6, v0
    v_and_b32 v0, 63, v0
    v_readfirstlane_b32 s6, v1
    s_mov_b32 s7, 0xffff0000
    s_lshl_b32 s8, s5, 6
    s_lshl_b32 s9, s6, 4
    s_add_u32 s9, s9, s8
    s_lshr_b32 s54, s5, 3
    s_lshl_b32 s54, s54, 1
    s_and_b32 s10, s5, 1
    s_add_u32 s54, s54, s10
    s_add_u32 s54, s54, s4
    s_and_b32 s54, s54, 7
    v_lshrrev_b32 v2, 3, v0
    v_and_b32 v3, 7, v0
    s_lshl_b32 s10, s4, 11
    s_add_u32 s10, s10, s9
    v_add_u32 v11, s10, v2
    v_lshlrev_b32 v11, 8, v11
    v_lshl_add_u32 v11, v3, 4, v11
    s_lshl_b32 s10, s54, 11
    s_add_u32 s10, s10, s9
    v_add_u32 v8, s10, v2
    v_lshlrev_b32 v10, 2, v8
    v_lshlrev_b32 v8, 9, v8
    v_lshl_add_u32 v8, v3, 5, v8
    v_add_u32 v9, 4096, v8
    v_add_u32 v12, s9, v2
    v_lshlrev_b32 v12, 8, v12
    v_lshl_add_u32 v12, v3, 4, v12
    v_and_b32 v13, 1, v0
    v_bfe_u32 v14, v0, 2, 2
    v_lshl_or_b32 v13, v14, 1, v13
    v_bfe_u32 v14, v0, 1, 1
    v_lshl_or_b32 v13, v14, 3, v13
    v_lshrrev_b32 v14, 5, v0
    v_lshl_or_b32 v13, v14, 4, v13
    v_bfe_u32 v15, v0, 4, 1
    v_lshlrev_b32 v16, 2, v15
    v_add_u32 v16, s10, v16
    v_lshlrev_b32 v17, 2, v16
    v_lshlrev_b32 v16, 9, v16
    v_lshl_add_u32 v16, v13, 4, v16
    v_add_u32 v18, 4096, v16
    v_mov_b32 v27, 0
    v_bfe_u32 v22, v0, 2, 3
    s_and_b32 s11, s5, 7
    s_lshl_b32 s11, s11, 0
    v_add_u32 v22, s11, v22
    v_and_b32 v22, 7, v22
    s_lshl_b32 s11, s6, 3
    v_add_u32 v22, s11, v22
    v_lshlrev_b32 v22, 7, v22
    v_and_b32 v23, 3, v0
    v_lshl_add_u32 v30, v23, 5, v22
    s_lshl_b32 s11, s4, 13
    s_add_u32 s11, s11, 16777216
    s_waitcnt lgkmcnt(0)
    s_add_u32 s56, s42, s11
    s_addc_u32 s57, s43, 0
    s_mov_b32 s0, 0
    s_and_b32 s1, s5, 7
    s_lshl_b32 s1, s1, 2
    s_getpc_b64 s[12:13]
M_pc0:
    s_add_u32 s12, s12, M_invtab-M_pc0
    s_addc_u32 s13, s13, 0
    v_lshlrev_b32 v22, 5, v3
    global_load_dwordx4 v[204:207], v22, s[12:13]
    global_load_dwordx4 v[208:211], v22, s[12:13] offset:16
    s_cmp_lg_u32 s2, 1
    s_cbranch_scc1 M_nononce
    s_cmp_lg_u32 s6, 3
    s_cbranch_scc1 M_nononce
    s_memrealtime s[46:47]
    s_waitcnt lgkmcnt(0)
    s_or_b32 s46, s46, 1
    v_mov_b32 v24, s46
    v_mov_b32 v25, s47
    s_mov_b64 exec, 1
    global_store_dwordx2 v27, v[24:25], s[40:41] sc1
    s_mov_b64 exec, -1
M_nononce:
    global_load_dwordx4 v[32:35], v8, s[18:19] offset:0 nt
    global_load_dwordx4 v[36:39], v8, s[18:19] offset:16 nt
    global_load_dwordx4 v[40:43], v8, s[18:19] offset:256 nt
    global_load_dwordx4 v[44:47], v8, s[18:19] offset:272 nt
    global_load_dwordx4 v[48:51], v9, s[18:19] offset:0 nt
    global_load_dwordx4 v[52:55], v9, s[18:19] offset:16 nt
    global_load_dwordx4 v[56:59], v9, s[18:19] offset:256 nt
    global_load_dwordx4 v[60:63], v9, s[18:19] offset:272 nt
    global_load_dword v96, v10, s[20:21] offset:0
    global_load_dword v97, v10, s[22:23] offset:0
    global_load_dword v98, v10, s[20:21] offset:32
    global_load_dword v99, v10, s[22:23] offset:32
    global_load_dwordx4 v[100:103], v16, s[24:25] offset:0 nt
    global_load_dwordx4 v[104:107], v16, s[24:25] offset:512 nt
    global_load_dwordx4 v[108:111], v16, s[24:25] offset:1024 nt
    global_load_dwordx4 v[112:115], v16, s[24:25] offset:1536 nt
    global_load_dwordx4 v[116:119], v18, s[24:25] offset:0 nt
    global_load_dwordx4 v[120:123], v18, s[24:25] offset:512 nt
    global_load_dwordx4 v[124:127], v18, s[24:25] offset:1024 nt
    global_load_dwordx4 v[128:131], v18, s[24:25] offset:1536 nt
    global_load_dwordx4 v[132:135], v17, s[26:27]
    global_load_dwordx4 v[136:139], v17, s[26:27] offset:32
    global_load_dwordx4 v[140:143], v17, s[28:29]
    global_load_dwordx4 v[144:147], v17, s[28:29] offset:32
    global_load_dwordx2 v[28:29], v27, s[40:41] sc1
    global_load_dwordx2 v[24:25], v30, s[56:57] sc1
    global_load_dwordx4 v[148:151], v11, s[16:17] offset:0 nt
    global_load_dwordx4 v[152:155], v11, s[16:17] offset:128 nt
    global_load_dwordx4 v[172:175], v11, s[16:17] offset:2048 nt
    global_load_dwordx4 v[176:179], v11, s[16:17] offset:2176 nt
    s_bfe_u32 s11, s5, 0x20001
    s_lshl_b32 s11, s11, 4
    s_lshr_b32 s12, s5, 3
    s_lshl_b32 s12, s12, 2
    s_add_u32 s11, s11, s12
    s_and_b32 s12, s5, 1
    s_lshl_b32 s12, s12, 1
    s_add_u32 s11, s11, s12
    s_lshr_b32 s12, s6, 1
    s_add_u32 s11, s11, s12
    s_and_b32 s59, s6, 1
    s_lshl_b32 s11, s11, 14
    s_lshl_b32 s12, s54, 20
    s_add_u32 s11, s11, s12
    s_add_u32 s11, s11, 0
    s_add_u32 s44, s42, s11
    s_addc_u32 s45, s43, 0
    v_mov_b32 v19, 0x01000c0c
    v_mul_u32_u24 v22, 0x0202, v14
    v_lshlrev_b32 v22, 16, v22
    v_add_u32 v19, v19, v22
    v_lshlrev_b32 v4, 4, v0
    v_add_u32 v5, 4096, v4
    v_add_u32 v6, 8192, v4
    v_add_u32 v7, 12288, v4
    s_mov_b32 s14, 0x05040100
    s_mov_b32 s15, 0x07060302
    s_lshl_b32 s13, s59, 7
    s_add_u32 s13, s13, 2048
    v_and_b32 v22, 3, v3
    v_lshlrev_b32 v20, 10, v22
    v_lshrrev_b32 v22, 2, v3
    v_lshl_add_u32 v20, v22, 9, v20
    v_lshl_add_u32 v20, v2, 4, v20
    v_add_u32 v20, s13, v20
    s_lshl_b32 s13, s59, 9
    s_add_u32 s13, s13, 12288
    v_and_b32 v22, 31, v0
    v_lshlrev_b32 v21, 4, v22
    v_lshl_add_u32 v21, v14, 10, v21
    v_add_u32 v21, s13, v21
    s_lshl_b32 s11, s4, 20
    s_lshl_b32 s12, s6, 18
    s_add_u32 s11, s11, s12
    s_add_u32 s11, s11, 0
    s_add_u32 s48, s42, s11
    s_addc_u32 s49, s43, 0
    s_mov_b32 s50, 0x40000
    s_mov_b32 s51, 0x20000
    v_and_b32 v22, 3, v3
    s_lshl_b32 s13, s6, 2
    v_add_u32 v22, s13, v22
    v_mul_u32_u24 v31, 1040, v22
    v_lshrrev_b32 v22, 2, v3
    v_lshl_add_u32 v31, v22, 9, v31
    v_lshl_add_u32 v31, v2, 4, v31
    v_add_u32 v31, 139520, v31
    s_bfe_u32 s8, s5, 0x20001
    s_lshl_b32 s8, s8, 3
    s_lshr_b32 s12, s5, 3
    s_lshl_b32 s12, s12, 1
    s_add_u32 s8, s8, s12
    s_and_b32 s12, s5, 1
    s_add_u32 s8, s8, s12
    s_lshl_b32 s8, s8, 7
    s_lshl_b32 s12, s6, 5
    s_add_u32 s8, s8, s12
    s_lshl_b32 s12, s54, 13
    s_add_u32 s8, s8, s12
    s_add_u32 s8, s8, 16777216
    s_mov_b32 s3, 0
    s_lshl_b32 s13, s6, 13
    v_add_u32 v8, s13, v4
    v_add_u32 v9, 0x10000, v8
    s_lshl_b32 s13, s6, 10
    s_add_u32 s13, s13, 131072
    v_lshlrev_b32 v10, 2, v0
    v_add_u32 v11, s13, v10
    s_lshl_b32 s13, s6, 8
    s_add_u32 s13, s13, 131072
    v_add_u32 v10, s13, v10
    s_lshl_b32 s13, s6, 15
    s_add_u32 s12, s6, 1
    s_and_b32 s12, s12, 3
    s_lshl_b32 s12, s12, 13
    s_add_u32 s12, s12, s13
    v_add_u32 v13, s12, v4
    s_add_u32 s12, s6, 2
    s_and_b32 s12, s12, 3
    s_lshl_b32 s12, s12, 13
    s_add_u32 s12, s12, s13
    v_add_u32 v14, s12, v4
    s_add_u32 s12, s6, 3
    s_and_b32 s12, s12, 3
    s_lshl_b32 s12, s12, 13
    s_add_u32 s12, s12, s13
    v_add_u32 v15, s12, v4
    s_lshl_b32 s13, s4, 11
    s_add_u32 s13, s13, s9
    v_and_b32 v12, 15, v0
    v_add_u32 v12, s13, v12
    v_lshlrev_b32 v12, 8, v12
    v_lshrrev_b32 v22, 4, v0
    v_lshl_add_u32 v12, v22, 4, v12
    s_waitcnt vmcnt(30)
    s_mov_b32 s12, 0x3e22f983
    s_mov_b32 s13, s12
    s_mov_b32 s58, 0x31dc9c88
    s_mov_b32 s59, s58
    v_add_u32 v22, s9, v2
    v_cvt_f32_u32 v22, v22
    v_pk_mul_f32 v[212:213], v[204:205], v[22:23] op_sel_hi:[1,0]
    v_pk_mul_f32 v[214:215], v[206:207], v[22:23] op_sel_hi:[1,0]
    v_pk_mul_f32 v[216:217], v[208:209], v[22:23] op_sel_hi:[1,0]
    v_pk_mul_f32 v[218:219], v[210:211], v[22:23] op_sel_hi:[1,0]
    v_pk_mul_f32 v[220:221], v[212:213], s[12:13]
    v_pk_mul_f32 v[222:223], v[214:215], s[12:13]
    v_pk_mul_f32 v[224:225], v[216:217], s[12:13]
    v_pk_mul_f32 v[226:227], v[218:219], s[12:13]
    v_pk_fma_f32 v[228:229], v[212:213], s[12:13], v[220:221] neg_lo:[0,0,1] neg_hi:[0,0,1]
    v_pk_fma_f32 v[230:231], v[214:215], s[12:13], v[222:223] neg_lo:[0,0,1] neg_hi:[0,0,1]
    v_pk_fma_f32 v[232:233], v[216:217], s[12:13], v[224:225] neg_lo:[0,0,1] neg_hi:[0,0,1]
    v_pk_fma_f32 v[234:235], v[218:219], s[12:13], v[226:227] neg_lo:[0,0,1] neg_hi:[0,0,1]
    v_fract_f32 v220, v220
    v_fract_f32 v221, v221
    v_fract_f32 v222, v222
    v_fract_f32 v223, v223
    v_fract_f32 v224, v224
    v_fract_f32 v225, v225
    v_fract_f32 v226, v226
    v_fract_f32 v227, v227
    v_pk_fma_f32 v[228:229], v[212:213], s[58:59], v[228:229]
    v_pk_fma_f32 v[230:231], v[214:215], s[58:59], v[230:231]
    v_pk_fma_f32 v[232:233], v[216:217], s[58:59], v[232:233]
    v_pk_fma_f32 v[234:235], v[218:219], s[58:59], v[234:235]
    v_pk_add_f32 v[220:221], v[220:221], v[228:229]
    v_pk_add_f32 v[222:223], v[222:223], v[230:231]
    v_pk_add_f32 v[224:225], v[224:225], v[232:233]
    v_pk_add_f32 v[226:227], v[226:227], v[234:235]
    v_cos_f32 v212, v220
    v_sin_f32 v228, v220
    v_cos_f32 v213, v221
    v_sin_f32 v229, v221
    v_cos_f32 v214, v222
    v_sin_f32 v230, v222
    v_cos_f32 v215, v223
    v_sin_f32 v231, v223
    v_cos_f32 v216, v224
    v_sin_f32 v232, v224
    v_cos_f32 v217, v225
    v_sin_f32 v233, v225
    v_cos_f32 v218, v226
    v_sin_f32 v234, v226
    v_cos_f32 v219, v227
    v_sin_f32 v235, v227
    v_cvt_pk_bf16_f32 v64, v212, v228
    v_cvt_pk_bf16_f32 v65, v213, v229
    v_cvt_pk_bf16_f32 v66, v214, v230
    v_cvt_pk_bf16_f32 v67, v215, v231
    v_cvt_pk_bf16_f32 v68, v216, v232
    v_cvt_pk_bf16_f32 v69, v217, v233
    v_cvt_pk_bf16_f32 v70, v218, v234
    v_cvt_pk_bf16_f32 v71, v219, v235
    v_alignbit_b32 v72, v64, v64, 16
    v_alignbit_b32 v73, v65, v65, 16
    v_alignbit_b32 v74, v66, v66, 16
    v_alignbit_b32 v75, v67, v67, 16
    v_alignbit_b32 v76, v68, v68, 16
    v_alignbit_b32 v77, v69, v69, 16
    v_alignbit_b32 v78, v70, v70, 16
    v_alignbit_b32 v79, v71, v71, 16
    v_add_u32 v22, s9, v2
    v_add_u32 v22, 8, v22
    v_cvt_f32_u32 v22, v22
    v_pk_mul_f32 v[212:213], v[204:205], v[22:23] op_sel_hi:[1,0]
    v_pk_mul_f32 v[214:215], v[206:207], v[22:23] op_sel_hi:[1,0]
    v_pk_mul_f32 v[216:217], v[208:209], v[22:23] op_sel_hi:[1,0]
    v_pk_mul_f32 v[218:219], v[210:211], v[22:23] op_sel_hi:[1,0]
    v_pk_mul_f32 v[220:221], v[212:213], s[12:13]
    v_pk_mul_f32 v[222:223], v[214:215], s[12:13]
    v_pk_mul_f32 v[224:225], v[216:217], s[12:13]
    v_pk_mul_f32 v[226:227], v[218:219], s[12:13]
    v_pk_fma_f32 v[228:229], v[212:213], s[12:13], v[220:221] neg_lo:[0,0,1] neg_hi:[0,0,1]
    v_pk_fma_f32 v[230:231], v[214:215], s[12:13], v[222:223] neg_lo:[0,0,1] neg_hi:[0,0,1]
    v_pk_fma_f32 v[232:233], v[216:217], s[12:13], v[224:225] neg_lo:[0,0,1] neg_hi:[0,0,1]
    v_pk_fma_f32 v[234:235], v[218:219], s[12:13], v[226:227] neg_lo:[0,0,1] neg_hi:[0,0,1]
    v_fract_f32 v220, v220
    v_fract_f32 v221, v221
    v_fract_f32 v222, v222
    v_fract_f32 v223, v223
    v_fract_f32 v224, v224
    v_fract_f32 v225, v225
    v_fract_f32 v226, v226
    v_fract_f32 v227, v227
    v_pk_fma_f32 v[228:229], v[212:213], s[58:59], v[228:229]
    v_pk_fma_f32 v[230:231], v[214:215], s[58:59], v[230:231]
    v_pk_fma_f32 v[232:233], v[216:217], s[58:59], v[232:233]
    v_pk_fma_f32 v[234:235], v[218:219], s[58:59], v[234:235]
    v_pk_add_f32 v[220:221], v[220:221], v[228:229]
    v_pk_add_f32 v[222:223], v[222:223], v[230:231]
    v_pk_add_f32 v[224:225], v[224:225], v[232:233]
    v_pk_add_f32 v[226:227], v[226:227], v[234:235]
    v_cos_f32 v212, v220
    v_sin_f32 v228, v220
    v_cos_f32 v213, v221
    v_sin_f32 v229, v221
    v_cos_f32 v214, v222
    v_sin_f32 v230, v222
    v_cos_f32 v215, v223
    v_sin_f32 v231, v223
    v_cos_f32 v216, v224
    v_sin_f32 v232, v224
    v_cos_f32 v217, v225
    v_sin_f32 v233, v225
    v_cos_f32 v218, v226
    v_sin_f32 v234, v226
    v_cos_f32 v219, v227
    v_sin_f32 v235, v227
    v_cvt_pk_bf16_f32 v80, v212, v228
    v_cvt_pk_bf16_f32 v81, v213, v229
    v_cvt_pk_bf16_f32 v82, v214, v230
    v_cvt_pk_bf16_f32 v83, v215, v231
    v_cvt_pk_bf16_f32 v84, v216, v232
    v_cvt_pk_bf16_f32 v85, v217, v233
    v_cvt_pk_bf16_f32 v86, v218, v234
    v_cvt_pk_bf16_f32 v87, v219, v235
    v_alignbit_b32 v88, v80, v80, 16
    v_alignbit_b32 v89, v81, v81, 16
    v_alignbit_b32 v90, v82, v82, 16
    v_alignbit_b32 v91, v83, v83, 16
    v_alignbit_b32 v92, v84, v84, 16
    v_alignbit_b32 v93, v85, v85, 16
    v_alignbit_b32 v94, v86, v86, 16
    v_alignbit_b32 v95, v87, v87, 16
    v_accvgpr_write_b32 a0, 0
    v_accvgpr_write_b32 a1, 0
    v_accvgpr_write_b32 a2, 0
    v_accvgpr_write_b32 a3, 0
    v_accvgpr_write_b32 a4, 0
    v_accvgpr_write_b32 a5, 0
    v_accvgpr_write_b32 a6, 0
    v_accvgpr_write_b32 a7, 0
    v_accvgpr_write_b32 a8, 0
    v_accvgpr_write_b32 a9, 0
    v_accvgpr_write_b32 a10, 0
    v_accvgpr_write_b32 a11, 0
    v_accvgpr_write_b32 a12, 0
    v_accvgpr_write_b32 a13, 0
    v_accvgpr_write_b32 a14, 0
    v_accvgpr_write_b32 a15, 0
    v_accvgpr_write_b32 a16, 0
    v_accvgpr_write_b32 a17, 0
    v_accvgpr_write_b32 a18, 0
    v_accvgpr_write_b32 a19, 0
    v_accvgpr_write_b32 a20, 0
    v_accvgpr_write_b32 a21, 0
    v_accvgpr_write_b32 a22, 0
    v_accvgpr_write_b32 a23, 0
    v_accvgpr_write_b32 a24, 0
    v_accvgpr_write_b32 a25, 0
    v_accvgpr_write_b32 a26, 0
    v_accvgpr_write_b32 a27, 0
    v_accvgpr_write_b32 a28, 0
    v_accvgpr_write_b32 a29, 0
    v_accvgpr_write_b32 a30, 0
    v_accvgpr_write_b32 a31, 0
    v_accvgpr_write_b32 a32, 0
    v_accvgpr_write_b32 a33, 0
    v_accvgpr_write_b32 a34, 0
    v_accvgpr_write_b32 a35, 0
    v_accvgpr_write_b32 a36, 0
    v_accvgpr_write_b32 a37, 0
    v_accvgpr_write_b32 a38, 0
    v_accvgpr_write_b32 a39, 0
    v_accvgpr_write_b32 a40, 0
    v_accvgpr_write_b32 a41, 0
    v_accvgpr_write_b32 a42, 0
    v_accvgpr_write_b32 a43, 0
    v_accvgpr_write_b32 a44, 0
    v_accvgpr_write_b32 a45, 0
    v_accvgpr_write_b32 a46, 0
    v_accvgpr_write_b32 a47, 0
    v_accvgpr_write_b32 a48, 0
    v_accvgpr_write_b32 a49, 0
    v_accvgpr_write_b32 a50, 0
    v_accvgpr_write_b32 a51, 0
    v_accvgpr_write_b32 a52, 0
    v_accvgpr_write_b32 a53, 0
    v_accvgpr_write_b32 a54, 0
    v_accvgpr_write_b32 a55, 0
    v_accvgpr_write_b32 a56, 0
    v_accvgpr_write_b32 a57, 0
    v_accvgpr_write_b32 a58, 0
    v_accvgpr_write_b32 a59, 0
    v_accvgpr_write_b32 a60, 0
    v_accvgpr_write_b32 a61, 0
    v_accvgpr_write_b32 a62, 0
    v_accvgpr_write_b32 a63, 0
    v_accvgpr_write_b32 a64, 0
    v_accvgpr_write_b32 a65, 0
    v_accvgpr_write_b32 a66, 0
    v_accvgpr_write_b32 a67, 0
    v_accvgpr_write_b32 a68, 0
    v_accvgpr_write_b32 a69, 0
    v_accvgpr_write_b32 a70, 0
    v_accvgpr_write_b32 a71, 0
    v_accvgpr_write_b32 a72, 0
    v_accvgpr_write_b32 a73, 0
    v_accvgpr_write_b32 a74, 0
    v_accvgpr_write_b32 a75, 0
    v_accvgpr_write_b32 a76, 0
    v_accvgpr_write_b32 a77, 0
    v_accvgpr_write_b32 a78, 0
    v_accvgpr_write_b32 a79, 0
    v_accvgpr_write_b32 a80, 0
    v_accvgpr_write_b32 a81, 0
    v_accvgpr_write_b32 a82, 0
    v_accvgpr_write_b32 a83, 0
    v_accvgpr_write_b32 a84, 0
    v_accvgpr_write_b32 a85, 0
    v_accvgpr_write_b32 a86, 0
    v_accvgpr_write_b32 a87, 0
    v_accvgpr_write_b32 a88, 0
    v_accvgpr_write_b32 a89, 0
    v_accvgpr_write_b32 a90, 0
    v_accvgpr_write_b32 a91, 0
    v_accvgpr_write_b32 a92, 0
    v_accvgpr_write_b32 a93, 0
    v_accvgpr_write_b32 a94, 0
    v_accvgpr_write_b32 a95, 0
    v_accvgpr_write_b32 a96, 0
    v_accvgpr_write_b32 a97, 0
    v_accvgpr_write_b32 a98, 0
    v_accvgpr_write_b32 a99, 0
    v_accvgpr_write_b32 a100, 0
    v_accvgpr_write_b32 a101, 0
    v_accvgpr_write_b32 a102, 0
    v_accvgpr_write_b32 a103, 0
    v_accvgpr_write_b32 a104, 0
    v_accvgpr_write_b32 a105, 0
    v_accvgpr_write_b32 a106, 0
    v_accvgpr_write_b32 a107, 0
    v_accvgpr_write_b32 a108, 0
    v_accvgpr_write_b32 a109, 0
    v_accvgpr_write_b32 a110, 0
    v_accvgpr_write_b32 a111, 0
    v_accvgpr_write_b32 a112, 0
    v_accvgpr_write_b32 a113, 0
    v_accvgpr_write_b32 a114, 0
    v_accvgpr_write_b32 a115, 0
    v_accvgpr_write_b32 a116, 0
    v_accvgpr_write_b32 a117, 0
    v_accvgpr_write_b32 a118, 0
    v_accvgpr_write_b32 a119, 0
    v_accvgpr_write_b32 a120, 0
    v_accvgpr_write_b32 a121, 0
    v_accvgpr_write_b32 a122, 0
    v_accvgpr_write_b32 a123, 0
    v_accvgpr_write_b32 a124, 0
    v_accvgpr_write_b32 a125, 0
    v_accvgpr_write_b32 a126, 0
    v_accvgpr_write_b32 a127, 0
    s_waitcnt vmcnt(18)
    v_lshlrev_b32 v236, 16, v96
    v_and_b32 v237, s7, v96
    v_lshlrev_b32 v238, 16, v97
    v_and_b32 v239, s7, v97
    v_cvt_f32_i32 v32, v32
    v_cvt_f32_i32 v33, v33
    v_cvt_f32_i32 v34, v34
    v_cvt_f32_i32 v35, v35
    v_cvt_f32_i32 v36, v36
    v_cvt_f32_i32 v37, v37
    v_cvt_f32_i32 v38, v38
    v_cvt_f32_i32 v39, v39
    v_cvt_f32_i32 v40, v40
    v_cvt_f32_i32 v41, v41
    v_cvt_f32_i32 v42, v42
    v_cvt_f32_i32 v43, v43
    v_cvt_f32_i32 v44, v44
    v_cvt_f32_i32 v45, v45
    v_cvt_f32_i32 v46, v46
    v_cvt_f32_i32 v47, v47
    v_pk_mul_f32 v[238:239], v[238:239], v[236:237]
    v_pk_fma_f32 v[32:33], v[32:33], v[236:237], v[238:239] op_sel_hi:[1,0,0] neg_lo:[0,0,1] neg_hi:[0,0,1]
    v_pk_fma_f32 v[40:41], v[40:41], v[236:237], v[238:239] op_sel:[0,1,1] op_sel_hi:[1,1,1] neg_lo:[0,0,1] neg_hi:[0,0,1]
    v_pk_fma_f32 v[34:35], v[34:35], v[236:237], v[238:239] op_sel_hi:[1,0,0] neg_lo:[0,0,1] neg_hi:[0,0,1]
    v_pk_fma_f32 v[42:43], v[42:43], v[236:237], v[238:239] op_sel:[0,1,1] op_sel_hi:[1,1,1] neg_lo:[0,0,1] neg_hi:[0,0,1]
    v_pk_fma_f32 v[36:37], v[36:37], v[236:237], v[238:239] op_sel_hi:[1,0,0] neg_lo:[0,0,1] neg_hi:[0,0,1]
    v_pk_fma_f32 v[44:45], v[44:45], v[236:237], v[238:239] op_sel:[0,1,1] op_sel_hi:[1,1,1] neg_lo:[0,0,1] neg_hi:[0,0,1]
    v_pk_fma_f32 v[38:39], v[38:39], v[236:237], v[238:239] op_sel_hi:[1,0,0] neg_lo:[0,0,1] neg_hi:[0,0,1]
    v_pk_fma_f32 v[46:47], v[46:47], v[236:237], v[238:239] op_sel:[0,1,1] op_sel_hi:[1,1,1] neg_lo:[0,0,1] neg_hi:[0,0,1]
    v_cvt_pk_bf16_f32 v212, v32, v40
    v_cvt_pk_bf16_f32 v213, v33, v41
    v_cvt_pk_bf16_f32 v214, v34, v42
    v_cvt_pk_bf16_f32 v215, v35, v43
    v_cvt_pk_bf16_f32 v216, v36, v44
    v_cvt_pk_bf16_f32 v217, v37, v45
    v_cvt_pk_bf16_f32 v218, v38, v46
    v_cvt_pk_bf16_f32 v219, v39, v47
    v_dot2_f32_bf16 v220, v212, v64, 0 neg_hi:[0,1,0]
    v_dot2_f32_bf16 v228, v212, v72, 0
    v_dot2_f32_bf16 v221, v213, v65, 0 neg_hi:[0,1,0]
    v_dot2_f32_bf16 v229, v213, v73, 0
    v_dot2_f32_bf16 v222, v214, v66, 0 neg_hi:[0,1,0]
    v_dot2_f32_bf16 v230, v214, v74, 0
    v_dot2_f32_bf16 v223, v215, v67, 0 neg_hi:[0,1,0]
    v_dot2_f32_bf16 v231, v215, v75, 0
    v_dot2_f32_bf16 v224, v216, v68, 0 neg_hi:[0,1,0]
    v_dot2_f32_bf16 v232, v216, v76, 0
    v_dot2_f32_bf16 v225, v217, v69, 0 neg_hi:[0,1,0]
    v_dot2_f32_bf16 v233, v217, v77, 0
    v_dot2_f32_bf16 v226, v218, v70, 0 neg_hi:[0,1,0]
    v_dot2_f32_bf16 v234, v218, v78, 0
    v_dot2_f32_bf16 v227, v219, v71, 0 neg_hi:[0,1,0]
    v_dot2_f32_bf16 v235, v219, v79, 0
    v_cvt_pk_bf16_f32 v240, v220, v221
    v_cvt_pk_bf16_f32 v241, v222, v223
    v_cvt_pk_bf16_f32 v242, v224, v225
    v_cvt_pk_bf16_f32 v243, v226, v227
    v_cvt_pk_bf16_f32 v244, v228, v229
    v_cvt_pk_bf16_f32 v245, v230, v231
    v_cvt_pk_bf16_f32 v246, v232, v233
    v_cvt_pk_bf16_f32 v247, v234, v235
    v_lshlrev_b32 v236, 16, v98
    v_and_b32 v237, s7, v98
    v_lshlrev_b32 v238, 16, v99
    v_and_b32 v239, s7, v99
    v_cvt_f32_i32 v48, v48
    v_cvt_f32_i32 v49, v49
    v_cvt_f32_i32 v50, v50
    v_cvt_f32_i32 v51, v51
    v_cvt_f32_i32 v52, v52
    v_cvt_f32_i32 v53, v53
    v_cvt_f32_i32 v54, v54
    v_cvt_f32_i32 v55, v55
    v_cvt_f32_i32 v56, v56
    v_cvt_f32_i32 v57, v57
    v_cvt_f32_i32 v58, v58
    v_cvt_f32_i32 v59, v59
    v_cvt_f32_i32 v60, v60
    v_cvt_f32_i32 v61, v61
    v_cvt_f32_i32 v62, v62
    v_cvt_f32_i32 v63, v63
    v_pk_mul_f32 v[238:239], v[238:239], v[236:237]
    v_pk_fma_f32 v[48:49], v[48:49], v[236:237], v[238:239] op_sel_hi:[1,0,0] neg_lo:[0,0,1] neg_hi:[0,0,1]
    v_pk_fma_f32 v[56:57], v[56:57], v[236:237], v[238:239] op_sel:[0,1,1] op_sel_hi:[1,1,1] neg_lo:[0,0,1] neg_hi:[0,0,1]
    v_pk_fma_f32 v[50:51], v[50:51], v[236:237], v[238:239] op_sel_hi:[1,0,0] neg_lo:[0,0,1] neg_hi:[0,0,1]
    v_pk_fma_f32 v[58:59], v[58:59], v[236:237], v[238:239] op_sel:[0,1,1] op_sel_hi:[1,1,1] neg_lo:[0,0,1] neg_hi:[0,0,1]
    v_pk_fma_f32 v[52:53], v[52:53], v[236:237], v[238:239] op_sel_hi:[1,0,0] neg_lo:[0,0,1] neg_hi:[0,0,1]
    v_pk_fma_f32 v[60:61], v[60:61], v[236:237], v[238:239] op_sel:[0,1,1] op_sel_hi:[1,1,1] neg_lo:[0,0,1] neg_hi:[0,0,1]
    v_pk_fma_f32 v[54:55], v[54:55], v[236:237], v[238:239] op_sel_hi:[1,0,0] neg_lo:[0,0,1] neg_hi:[0,0,1]
    v_pk_fma_f32 v[62:63], v[62:63], v[236:237], v[238:239] op_sel:[0,1,1] op_sel_hi:[1,1,1] neg_lo:[0,0,1] neg_hi:[0,0,1]
    v_cvt_pk_bf16_f32 v212, v48, v56
    v_cvt_pk_bf16_f32 v213, v49, v57
    v_cvt_pk_bf16_f32 v214, v50, v58
    v_cvt_pk_bf16_f32 v215, v51, v59
    v_cvt_pk_bf16_f32 v216, v52, v60
    v_cvt_pk_bf16_f32 v217, v53, v61
    v_cvt_pk_bf16_f32 v218, v54, v62
    v_cvt_pk_bf16_f32 v219, v55, v63
    v_dot2_f32_bf16 v220, v212, v80, 0 neg_hi:[0,1,0]
    v_dot2_f32_bf16 v228, v212, v88, 0
    v_dot2_f32_bf16 v221, v213, v81, 0 neg_hi:[0,1,0]
    v_dot2_f32_bf16 v229, v213, v89, 0
    v_dot2_f32_bf16 v222, v214, v82, 0 neg_hi:[0,1,0]
    v_dot2_f32_bf16 v230, v214, v90, 0
    v_dot2_f32_bf16 v223, v215, v83, 0 neg_hi:[0,1,0]
    v_dot2_f32_bf16 v231, v215, v91, 0
    v_dot2_f32_bf16 v224, v216, v84, 0 neg_hi:[0,1,0]
    v_dot2_f32_bf16 v232, v216, v92, 0
    v_dot2_f32_bf16 v225, v217, v85, 0 neg_hi:[0,1,0]
    v_dot2_f32_bf16 v233, v217, v93, 0
    v_dot2_f32_bf16 v226, v218, v86, 0 neg_hi:[0,1,0]
    v_dot2_f32_bf16 v234, v218, v94, 0
    v_dot2_f32_bf16 v227, v219, v87, 0 neg_hi:[0,1,0]
    v_dot2_f32_bf16 v235, v219, v95, 0
    v_cvt_pk_bf16_f32 v248, v220, v221
    v_cvt_pk_bf16_f32 v249, v222, v223
    v_cvt_pk_bf16_f32 v250, v224, v225
    v_cvt_pk_bf16_f32 v251, v226, v227
    v_cvt_pk_bf16_f32 v252, v228, v229
    v_cvt_pk_bf16_f32 v253, v230, v231
    v_cvt_pk_bf16_f32 v254, v232, v233
    v_cvt_pk_bf16_f32 v255, v234, v235
    s_waitcnt vmcnt(6)
    v_perm_b32 v196, v132, v132, v19
    v_perm_b32 v197, v140, v140, v19
    v_cvt_f32_i32 v100, v100
    v_cvt_f32_i32 v101, v101
    v_cvt_f32_i32 v102, v102
    v_cvt_f32_i32 v103, v103
    v_mul_f32 v197, v197, v196
    v_perm_b32 v198, v133, v133, v19
    v_perm_b32 v199, v141, v141, v19
    v_cvt_f32_i32 v104, v104
    v_cvt_f32_i32 v105, v105
    v_cvt_f32_i32 v106, v106
    v_cvt_f32_i32 v107, v107
    v_mul_f32 v199, v199, v198
    v_perm_b32 v200, v134, v134, v19
    v_perm_b32 v201, v142, v142, v19
    v_cvt_f32_i32 v108, v108
    v_cvt_f32_i32 v109, v109
    v_cvt_f32_i32 v110, v110
    v_cvt_f32_i32 v111, v111
    v_mul_f32 v201, v201, v200
    v_perm_b32 v202, v135, v135, v19
    v_perm_b32 v203, v143, v143, v19
    v_cvt_f32_i32 v112, v112
    v_cvt_f32_i32 v113, v113
    v_cvt_f32_i32 v114, v114
    v_cvt_f32_i32 v115, v115
    v_mul_f32 v203, v203, v202
    v_perm_b32 v204, v136, v136, v19
    v_perm_b32 v205, v144, v144, v19
    v_cvt_f32_i32 v116, v116
    v_cvt_f32_i32 v117, v117
    v_cvt_f32_i32 v118, v118
    v_cvt_f32_i32 v119, v119
    v_mul_f32 v205, v205, v204
    v_perm_b32 v206, v137, v137, v19
    v_perm_b32 v207, v145, v145, v19
    v_cvt_f32_i32 v120, v120
    v_cvt_f32_i32 v121, v121
    v_cvt_f32_i32 v122, v122
    v_cvt_f32_i32 v123, v123
    v_mul_f32 v207, v207, v206
    v_perm_b32 v208, v138, v138, v19
    v_perm_b32 v209, v146, v146, v19
    v_cvt_f32_i32 v124, v124
    v_cvt_f32_i32 v125, v125
    v_cvt_f32_i32 v126, v126
    v_cvt_f32_i32 v127, v127
    v_mul_f32 v209, v209, v208
    v_perm_b32 v210, v139, v139, v19
    v_perm_b32 v211, v147, v147, v19
    v_cvt_f32_i32 v128, v128
    v_cvt_f32_i32 v129, v129
    v_cvt_f32_i32 v130, v130
    v_cvt_f32_i32 v131, v131
    v_mul_f32 v211, v211, v210
    v_pk_fma_f32 v[100:101], v[100:101], v[196:197], v[196:197] op_sel:[0,0,1] op_sel_hi:[1,0,1] neg_lo:[0,0,1] neg_hi:[0,0,1]
    v_pk_fma_f32 v[102:103], v[102:103], v[196:197], v[196:197] op_sel:[0,0,1] op_sel_hi:[1,0,1] neg_lo:[0,0,1] neg_hi:[0,0,1]
    v_pk_fma_f32 v[104:105], v[104:105], v[198:199], v[198:199] op_sel:[0,0,1] op_sel_hi:[1,0,1] neg_lo:[0,0,1] neg_hi:[0,0,1]
    v_pk_fma_f32 v[106:107], v[106:107], v[198:199], v[198:199] op_sel:[0,0,1] op_sel_hi:[1,0,1] neg_lo:[0,0,1] neg_hi:[0,0,1]
    v_pk_fma_f32 v[108:109], v[108:109], v[200:201], v[200:201] op_sel:[0,0,1] op_sel_hi:[1,0,1] neg_lo:[0,0,1] neg_hi:[0,0,1]
    v_pk_fma_f32 v[110:111], v[110:111], v[200:201], v[200:201] op_sel:[0,0,1] op_sel_hi:[1,0,1] neg_lo:[0,0,1] neg_hi:[0,0,1]
    v_pk_fma_f32 v[112:113], v[112:113], v[202:203], v[202:203] op_sel:[0,0,1] op_sel_hi:[1,0,1] neg_lo:[0,0,1] neg_hi:[0,0,1]
    v_pk_fma_f32 v[114:115], v[114:115], v[202:203], v[202:203] op_sel:[0,0,1] op_sel_hi:[1,0,1] neg_lo:[0,0,1] neg_hi:[0,0,1]
    v_pk_fma_f32 v[116:117], v[116:117], v[204:205], v[204:205] op_sel:[0,0,1] op_sel_hi:[1,0,1] neg_lo:[0,0,1] neg_hi:[0,0,1]
    v_pk_fma_f32 v[118:119], v[118:119], v[204:205], v[204:205] op_sel:[0,0,1] op_sel_hi:[1,0,1] neg_lo:[0,0,1] neg_hi:[0,0,1]
    v_pk_fma_f32 v[120:121], v[120:121], v[206:207], v[206:207] op_sel:[0,0,1] op_sel_hi:[1,0,1] neg_lo:[0,0,1] neg_hi:[0,0,1]
    v_pk_fma_f32 v[122:123], v[122:123], v[206:207], v[206:207] op_sel:[0,0,1] op_sel_hi:[1,0,1] neg_lo:[0,0,1] neg_hi:[0,0,1]
    v_pk_fma_f32 v[124:125], v[124:125], v[208:209], v[208:209] op_sel:[0,0,1] op_sel_hi:[1,0,1] neg_lo:[0,0,1] neg_hi:[0,0,1]
    v_pk_fma_f32 v[126:127], v[126:127], v[208:209], v[208:209] op_sel:[0,0,1] op_sel_hi:[1,0,1] neg_lo:[0,0,1] neg_hi:[0,0,1]
    v_pk_fma_f32 v[128:129], v[128:129], v[210:211], v[210:211] op_sel:[0,0,1] op_sel_hi:[1,0,1] neg_lo:[0,0,1] neg_hi:[0,0,1]
    v_pk_fma_f32 v[130:131], v[130:131], v[210:211], v[210:211] op_sel:[0,0,1] op_sel_hi:[1,0,1] neg_lo:[0,0,1] neg_hi:[0,0,1]
    v_cvt_pk_bf16_f32 v224, v100, v104
    v_cvt_pk_bf16_f32 v225, v108, v112
    v_cvt_pk_bf16_f32 v226, v116, v120
    v_cvt_pk_bf16_f32 v227, v124, v128
    v_cvt_pk_bf16_f32 v228, v101, v105
    v_cvt_pk_bf16_f32 v229, v109, v113
    v_cvt_pk_bf16_f32 v230, v117, v121
    v_cvt_pk_bf16_f32 v231, v125, v129
    v_cvt_pk_bf16_f32 v232, v102, v106
    v_cvt_pk_bf16_f32 v233, v110, v114
    v_cvt_pk_bf16_f32 v234, v118, v122
    v_cvt_pk_bf16_f32 v235, v126, v130
    v_cvt_pk_bf16_f32 v236, v103, v107
    v_cvt_pk_bf16_f32 v237, v111, v115
    v_cvt_pk_bf16_f32 v238, v119, v123
    v_cvt_pk_bf16_f32 v239, v127, v131
    s_waitcnt vmcnt(4)
    s_mov_b32 s58, 0
M_nchka:
    v_readfirstlane_b32 s46, v28
    v_readfirstlane_b32 s47, v29
    s_nop 0
    s_or_b32 s13, s46, s47
    s_cmp_lg_u32 s13, 0
    s_cbranch_scc1 M_noka
    s_add_u32 s58, s58, 1
    s_cmp_gt_u32 s58, 4000
    s_cbranch_scc1 M_noka
    global_load_dwordx2 v[28:29], v27, s[40:41] sc1
    s_waitcnt vmcnt(0)
    s_branch M_nchka
M_noka:
    v_cmp_eq_u64 vcc, v[24:25], s[46:47]
    s_nop 1
    s_lshr_b32 s58, vcc_lo, 1
    s_and_b32 s58, s58, vcc_lo
    s_lshr_b32 s59, s58, 2
    s_and_b32 s58, s58, s59
    s_and_b32 s58, s58, 0x11111111
    s_bcnt1_i32_b32 s59, s58
    s_cmp_ge_u32 s59, 2
    s_cbranch_scc0 M_pathB
    s_ff1_i32_b32 s59, s58
    s_mov_b32 s55, 0
    s_bitset1_b32 s55, s59
    s_add_u32 s59, s59, s1
    s_and_b32 s59, s59, 31
    s_lshl_b32 s100, s59, 13
    s_andn2_b32 s58, s58, s55
    s_ff1_i32_b32 s59, s58
    s_bitset1_b32 s55, s59
    s_add_u32 s59, s59, s1
    s_and_b32 s59, s59, 31
    s_lshl_b32 s101, s59, 13
    s_mov_b32 s52, s100
    buffer_load_dwordx4 a[192:195], v4, s[48:51], s52 offen offset:0 sc1
    buffer_load_dwordx4 a[208:211], v5, s[48:51], s52 offen offset:0 sc1
    buffer_load_dwordx4 a[196:199], v4, s[48:51], s52 offen offset:1024 sc1
    buffer_load_dwordx4 a[212:215], v5, s[48:51], s52 offen offset:1024 sc1
    buffer_load_dwordx4 a[200:203], v4, s[48:51], s52 offen offset:2048 sc1
    buffer_load_dwordx4 a[216:219], v5, s[48:51], s52 offen offset:2048 sc1
    buffer_load_dwordx4 a[204:207], v4, s[48:51], s52 offen offset:3072 sc1
    buffer_load_dwordx4 a[220:223], v5, s[48:51], s52 offen offset:3072 sc1
    s_add_u32 s52, s100, 16384
    buffer_load_dwordx4 a[224:227], v4, s[48:51], s52 offen offset:0 sc1
    buffer_load_dwordx4 a[240:243], v5, s[48:51], s52 offen offset:0 sc1
    buffer_load_dwordx4 a[228:231], v4, s[48:51], s52 offen offset:1024 sc1
    buffer_load_dwordx4 a[244:247], v5, s[48:51], s52 offen offset:1024 sc1
    buffer_load_dwordx4 a[232:235], v4, s[48:51], s52 offen offset:2048 sc1
    buffer_load_dwordx4 a[248:251], v5, s[48:51], s52 offen offset:2048 sc1
    buffer_load_dwordx4 a[236:239], v4, s[48:51], s52 offen offset:3072 sc1
    buffer_load_dwordx4 a[252:255], v5, s[48:51], s52 offen offset:3072 sc1
    s_mov_b32 s3, 1
    global_store_dwordx4 v20, v[240:243], s[44:45] offset:-2048 sc1
    global_store_dwordx4 v20, v[244:247], s[44:45] offset:-1792 sc1
    global_store_dwordx4 v20, v[248:251], s[44:45] offset:2048 sc1
    global_store_dwordx4 v20, v[252:255], s[44:45] offset:2304 sc1
    global_store_dwordx4 v21, v[224:227], s[44:45] offset:-4096 sc1
    global_store_dwordx4 v21, v[228:231], s[44:45] offset:-2048 sc1
    global_store_dwordx4 v21, v[232:235], s[44:45] offset:0 sc1
    global_store_dwordx4 v21, v[236:239], s[44:45] offset:2048 sc1
    s_waitcnt vmcnt(24)
    s_branch M_qp
M_pathB:
    global_store_dwordx4 v20, v[240:243], s[44:45] offset:-2048 sc1
    global_store_dwordx4 v20, v[244:247], s[44:45] offset:-1792 sc1
    global_store_dwordx4 v20, v[248:251], s[44:45] offset:2048 sc1
    global_store_dwordx4 v20, v[252:255], s[44:45] offset:2304 sc1
    global_store_dwordx4 v21, v[224:227], s[44:45] offset:-4096 sc1
    global_store_dwordx4 v21, v[228:231], s[44:45] offset:-2048 sc1
    global_store_dwordx4 v21, v[232:235], s[44:45] offset:0 sc1
    global_store_dwordx4 v21, v[236:239], s[44:45] offset:2048 sc1
    s_waitcnt vmcnt(8)
M_qp:
    s_mov_b32 s12, 0x3e0293ee
    s_mov_b32 s13, s12
    v_perm_b32 v116, v152, v148, s14
    v_perm_b32 v117, v152, v148, s15
    v_perm_b32 v118, v153, v149, s14
    v_perm_b32 v119, v153, v149, s15
    v_perm_b32 v120, v154, v150, s14
    v_perm_b32 v121, v154, v150, s15
    v_perm_b32 v122, v155, v151, s14
    v_perm_b32 v123, v155, v151, s15
    v_dot2_f32_bf16 v124, v116, v64, 0 neg_hi:[0,1,0]
    v_dot2_f32_bf16 v132, v116, v72, 0
    v_dot2_f32_bf16 v125, v117, v65, 0 neg_hi:[0,1,0]
    v_dot2_f32_bf16 v133, v117, v73, 0
    v_dot2_f32_bf16 v126, v118, v66, 0 neg_hi:[0,1,0]
    v_dot2_f32_bf16 v134, v118, v74, 0
    v_dot2_f32_bf16 v127, v119, v67, 0 neg_hi:[0,1,0]
    v_dot2_f32_bf16 v135, v119, v75, 0
    v_dot2_f32_bf16 v128, v120, v68, 0 neg_hi:[0,1,0]
    v_dot2_f32_bf16 v136, v120, v76, 0
    v_dot2_f32_bf16 v129, v121, v69, 0 neg_hi:[0,1,0]
    v_dot2_f32_bf16 v137, v121, v77, 0
    v_dot2_f32_bf16 v130, v122, v70, 0 neg_hi:[0,1,0]
    v_dot2_f32_bf16 v138, v122, v78, 0
    v_dot2_f32_bf16 v131, v123, v71, 0 neg_hi:[0,1,0]
    v_dot2_f32_bf16 v139, v123, v79, 0
    v_pk_mul_f32 v[124:125], v[124:125], s[12:13]
    v_pk_mul_f32 v[132:133], v[132:133], s[12:13]
    v_pk_mul_f32 v[126:127], v[126:127], s[12:13]
    v_pk_mul_f32 v[134:135], v[134:135], s[12:13]
    v_pk_mul_f32 v[128:129], v[128:129], s[12:13]
    v_pk_mul_f32 v[136:137], v[136:137], s[12:13]
    v_pk_mul_f32 v[130:131], v[130:131], s[12:13]
    v_pk_mul_f32 v[138:139], v[138:139], s[12:13]
    v_cvt_pk_bf16_f32 v48, v124, v125
    v_cvt_pk_bf16_f32 v49, v126, v127
    v_cvt_pk_bf16_f32 v50, v128, v129
    v_cvt_pk_bf16_f32 v51, v130, v131
    v_cvt_pk_bf16_f32 v52, v132, v133
    v_cvt_pk_bf16_f32 v53, v134, v135
    v_cvt_pk_bf16_f32 v54, v136, v137
    v_cvt_pk_bf16_f32 v55, v138, v139
    ds_write_b128 v31, v[48:51] offset:0
    ds_write_b128 v31, v[52:55] offset:256
    v_perm_b32 v116, v176, v172, s14
    v_perm_b32 v117, v176, v172, s15
    v_perm_b32 v118, v177, v173, s14
    v_perm_b32 v119, v177, v173, s15
    v_perm_b32 v120, v178, v174, s14
    v_perm_b32 v121, v178, v174, s15
    v_perm_b32 v122, v179, v175, s14
    v_perm_b32 v123, v179, v175, s15
    v_dot2_f32_bf16 v124, v116, v80, 0 neg_hi:[0,1,0]
    v_dot2_f32_bf16 v132, v116, v88, 0
    v_dot2_f32_bf16 v125, v117, v81, 0 neg_hi:[0,1,0]
    v_dot2_f32_bf16 v133, v117, v89, 0
    v_dot2_f32_bf16 v126, v118, v82, 0 neg_hi:[0,1,0]
    v_dot2_f32_bf16 v134, v118, v90, 0
    v_dot2_f32_bf16 v127, v119, v83, 0 neg_hi:[0,1,0]
    v_dot2_f32_bf16 v135, v119, v91, 0
    v_dot2_f32_bf16 v128, v120, v84, 0 neg_hi:[0,1,0]
    v_dot2_f32_bf16 v136, v120, v92, 0
    v_dot2_f32_bf16 v129, v121, v85, 0 neg_hi:[0,1,0]
    v_dot2_f32_bf16 v137, v121, v93, 0
    v_dot2_f32_bf16 v130, v122, v86, 0 neg_hi:[0,1,0]
    v_dot2_f32_bf16 v138, v122, v94, 0
    v_dot2_f32_bf16 v131, v123, v87, 0 neg_hi:[0,1,0]
    v_dot2_f32_bf16 v139, v123, v95, 0
    v_pk_mul_f32 v[124:125], v[124:125], s[12:13]
    v_pk_mul_f32 v[132:133], v[132:133], s[12:13]
    v_pk_mul_f32 v[126:127], v[126:127], s[12:13]
    v_pk_mul_f32 v[134:135], v[134:135], s[12:13]
    v_pk_mul_f32 v[128:129], v[128:129], s[12:13]
    v_pk_mul_f32 v[136:137], v[136:137], s[12:13]
    v_pk_mul_f32 v[130:131], v[130:131], s[12:13]
    v_pk_mul_f32 v[138:139], v[138:139], s[12:13]
    v_cvt_pk_bf16_f32 v56, v124, v125
    v_cvt_pk_bf16_f32 v57, v126, v127
    v_cvt_pk_bf16_f32 v58, v128, v129
    v_cvt_pk_bf16_f32 v59, v130, v131
    v_cvt_pk_bf16_f32 v60, v132, v133
    v_cvt_pk_bf16_f32 v61, v134, v135
    v_cvt_pk_bf16_f32 v62, v136, v137
    v_cvt_pk_bf16_f32 v63, v138, v139
    ds_write_b128 v31, v[56:59] offset:128
    ds_write_b128 v31, v[60:63] offset:384
    s_waitcnt lgkmcnt(0)
    s_barrier
    v_add_u32 v26, 139520, v4
    ds_read_b128 a[128:131], v26 offset:0
    ds_read_b128 a[132:135], v26 offset:1040
    ds_read_b128 a[136:139], v26 offset:2080
    ds_read_b128 a[140:143], v26 offset:3120
    ds_read_b128 a[144:147], v26 offset:4160
    ds_read_b128 a[148:151], v26 offset:5200
    ds_read_b128 a[152:155], v26 offset:6240
    ds_read_b128 a[156:159], v26 offset:7280
    ds_read_b128 a[160:163], v26 offset:8320
    ds_read_b128 a[164:167], v26 offset:9360
    ds_read_b128 a[168:171], v26 offset:10400
    ds_read_b128 a[172:175], v26 offset:11440
    ds_read_b128 a[176:179], v26 offset:12480
    ds_read_b128 a[180:183], v26 offset:13520
    ds_read_b128 a[184:187], v26 offset:14560
    ds_read_b128 a[188:191], v26 offset:15600
    s_cmp_eq_u32 s3, 0
    s_cbranch_scc1 M_publish
    s_mov_b32 s53, s100
    buffer_load_dwordx4 v[128:131], v6, s[48:51], s53 offen offset:0 sc1
    buffer_load_dwordx4 v[132:135], v6, s[48:51], s53 offen offset:1024 sc1
    buffer_load_dwordx4 v[136:139], v6, s[48:51], s53 offen offset:2048 sc1
    buffer_load_dwordx4 v[140:143], v6, s[48:51], s53 offen offset:3072 sc1
    buffer_load_dwordx4 v[144:147], v7, s[48:51], s53 offen offset:0 sc1
    buffer_load_dwordx4 v[148:151], v7, s[48:51], s53 offen offset:1024 sc1
    buffer_load_dwordx4 v[152:155], v7, s[48:51], s53 offen offset:2048 sc1
    buffer_load_dwordx4 v[156:159], v7, s[48:51], s53 offen offset:3072 sc1
    s_waitcnt vmcnt(24) lgkmcnt(0)
    s_branch M_pc
M_publish:
    s_waitcnt vmcnt(0)
    v_mov_b32 v22, s46
    v_mov_b32 v23, s47
    v_mov_b32 v24, s8
    s_mov_b64 exec, 1
    global_store_dwordx2 v24, v[22:23], s[42:43] sc1
    s_mov_b64 exec, -1
    global_load_dwordx2 v[84:85], v30, s[56:57] sc1
    s_mov_b32 s13, 0
M_poll0:
    s_waitcnt vmcnt(0)
    v_cmp_eq_u64 vcc, v[84:85], s[46:47]
    s_add_u32 s13, s13, 1
    s_nop 0
    s_lshr_b32 s58, vcc_lo, 1
    s_and_b32 s58, s58, vcc_lo
    s_lshr_b32 s59, s58, 2
    s_and_b32 s58, s58, s59
    s_and_b32 s58, s58, 0x11111111
    s_bcnt1_i32_b32 s59, s58
    s_cmp_ge_u32 s59, 2
    s_cbranch_scc1 M_poll0_ok
    global_load_dwordx2 v[84:85], v30, s[56:57] sc1
    s_cmp_gt_u32 s13, 4000
    s_cbranch_scc0 M_poll0
    s_waitcnt vmcnt(0)
    s_mov_b32 s58, 0x11111111
M_poll0_ok:
    s_ff1_i32_b32 s59, s58
    s_mov_b32 s55, 0
    s_bitset1_b32 s55, s59
    s_add_u32 s59, s59, s1
    s_and_b32 s59, s59, 31
    s_lshl_b32 s100, s59, 13
    s_andn2_b32 s58, s58, s55
    s_ff1_i32_b32 s59, s58
    s_bitset1_b32 s55, s59
    s_add_u32 s59, s59, s1
    s_and_b32 s59, s59, 31
    s_lshl_b32 s101, s59, 13
    s_mov_b32 s52, s100
    buffer_load_dwordx4 a[192:195], v4, s[48:51], s52 offen offset:0 sc1
    buffer_load_dwordx4 a[208:211], v5, s[48:51], s52 offen offset:0 sc1
    buffer_load_dwordx4 a[196:199], v4, s[48:51], s52 offen offset:1024 sc1
    buffer_load_dwordx4 a[212:215], v5, s[48:51], s52 offen offset:1024 sc1
    buffer_load_dwordx4 a[200:203], v4, s[48:51], s52 offen offset:2048 sc1
    buffer_load_dwordx4 a[216:219], v5, s[48:51], s52 offen offset:2048 sc1
    buffer_load_dwordx4 a[204:207], v4, s[48:51], s52 offen offset:3072 sc1
    buffer_load_dwordx4 a[220:223], v5, s[48:51], s52 offen offset:3072 sc1
    s_add_u32 s52, s100, 16384
    buffer_load_dwordx4 a[224:227], v4, s[48:51], s52 offen offset:0 sc1
    buffer_load_dwordx4 a[240:243], v5, s[48:51], s52 offen offset:0 sc1
    buffer_load_dwordx4 a[228:231], v4, s[48:51], s52 offen offset:1024 sc1
    buffer_load_dwordx4 a[244:247], v5, s[48:51], s52 offen offset:1024 sc1
    buffer_load_dwordx4 a[232:235], v4, s[48:51], s52 offen offset:2048 sc1
    buffer_load_dwordx4 a[248:251], v5, s[48:51], s52 offen offset:2048 sc1
    buffer_load_dwordx4 a[236:239], v4, s[48:51], s52 offen offset:3072 sc1
    buffer_load_dwordx4 a[252:255], v5, s[48:51], s52 offen offset:3072 sc1
    s_mov_b32 s53, s100
    buffer_load_dwordx4 v[128:131], v6, s[48:51], s53 offen offset:0 sc1
    buffer_load_dwordx4 v[132:135], v6, s[48:51], s53 offen offset:1024 sc1
    buffer_load_dwordx4 v[136:139], v6, s[48:51], s53 offen offset:2048 sc1
    buffer_load_dwordx4 v[140:143], v6, s[48:51], s53 offen offset:3072 sc1
    buffer_load_dwordx4 v[144:147], v7, s[48:51], s53 offen offset:0 sc1
    buffer_load_dwordx4 v[148:151], v7, s[48:51], s53 offen offset:1024 sc1
    buffer_load_dwordx4 v[152:155], v7, s[48:51], s53 offen offset:2048 sc1
    buffer_load_dwordx4 v[156:159], v7, s[48:51], s53 offen offset:3072 sc1
    v_mov_b32 v96, 0
    v_mov_b32 v97, 0
    v_mov_b32 v98, 0
    v_mov_b32 v99, 0
    v_mov_b32 v100, 0
    v_mov_b32 v101, 0
    v_mov_b32 v102, 0
    v_mov_b32 v103, 0
    v_mov_b32 v104, 0
    v_mov_b32 v105, 0
    v_mov_b32 v106, 0
    v_mov_b32 v107, 0
    v_mov_b32 v108, 0
    v_mov_b32 v109, 0
    v_mov_b32 v110, 0
    v_mov_b32 v111, 0
    v_mov_b32 v88, 0x3f803f80
    v_mov_b32 v89, 0x3f803f80
    v_mov_b32 v90, 0x3f803f80
    v_mov_b32 v91, 0x3f803f80
    s_waitcnt vmcnt(16) lgkmcnt(0)
    s_branch M_pc2
M_pc:
    v_mov_b32 v96, 0
    v_mov_b32 v97, 0
    v_mov_b32 v98, 0
    v_mov_b32 v99, 0
    v_mov_b32 v100, 0
    v_mov_b32 v101, 0
    v_mov_b32 v102, 0
    v_mov_b32 v103, 0
    v_mov_b32 v104, 0
    v_mov_b32 v105, 0
    v_mov_b32 v106, 0
    v_mov_b32 v107, 0
    v_mov_b32 v108, 0
    v_mov_b32 v109, 0
    v_mov_b32 v110, 0
    v_mov_b32 v111, 0
    v_mov_b32 v88, 0x3f803f80
    v_mov_b32 v89, 0x3f803f80
    v_mov_b32 v90, 0x3f803f80
    v_mov_b32 v91, 0x3f803f80
M_pc2:
    s_mov_b32 s52, s101
    s_add_u32 s53, s100, 16384
    v_mfma_f32_16x16x32_bf16 v[32:35], a[192:195], a[128:131], 0
    v_mfma_f32_16x16x32_bf16 v[40:43], a[192:195], a[144:147], 0
    v_mfma_f32_16x16x32_bf16 v[36:39], a[208:211], a[128:131], 0
    v_mfma_f32_16x16x32_bf16 v[44:47], a[208:211], a[144:147], 0
    v_mfma_f32_16x16x32_bf16 v[32:35], a[196:199], a[132:135], v[32:35]
    v_mfma_f32_16x16x32_bf16 v[40:43], a[196:199], a[148:151], v[40:43]
    v_mfma_f32_16x16x32_bf16 v[36:39], a[212:215], a[132:135], v[36:39]
    v_mfma_f32_16x16x32_bf16 v[44:47], a[212:215], a[148:151], v[44:47]
    v_mfma_f32_16x16x32_bf16 v[32:35], a[200:203], a[136:139], v[32:35]
    v_mfma_f32_16x16x32_bf16 v[40:43], a[200:203], a[152:155], v[40:43]
    v_mfma_f32_16x16x32_bf16 v[36:39], a[216:219], a[136:139], v[36:39]
    v_mfma_f32_16x16x32_bf16 v[44:47], a[216:219], a[152:155], v[44:47]
    v_mfma_f32_16x16x32_bf16 v[32:35], a[204:207], a[140:143], v[32:35]
    v_mfma_f32_16x16x32_bf16 v[40:43], a[204:207], a[156:159], v[40:43]
    v_mfma_f32_16x16x32_bf16 v[36:39], a[220:223], a[140:143], v[36:39]
    v_mfma_f32_16x16x32_bf16 v[44:47], a[220:223], a[156:159], v[44:47]
    v_mfma_f32_16x16x32_bf16 v[48:51], a[192:195], a[160:163], 0
    s_nop 0
    v_mfma_f32_16x16x32_bf16 v[56:59], a[192:195], a[176:179], 0
    v_mfma_f32_16x16x32_bf16 v[52:55], a[208:211], a[160:163], 0
    s_nop 0
    v_mfma_f32_16x16x32_bf16 v[60:63], a[208:211], a[176:179], 0
    v_mfma_f32_16x16x32_bf16 v[48:51], a[196:199], a[164:167], v[48:51]
    s_nop 0
    v_mfma_f32_16x16x32_bf16 v[56:59], a[196:199], a[180:183], v[56:59]
    v_exp_f32 v32, v32
    v_mfma_f32_16x16x32_bf16 v[52:55], a[212:215], a[164:167], v[52:55]
    s_nop 0
    v_exp_f32 v33, v33
    v_mfma_f32_16x16x32_bf16 v[60:63], a[212:215], a[180:183], v[60:63]
    v_cvt_pk_bf16_f32 v64, v32, v33
    v_mfma_f32_16x16x32_bf16 v[48:51], a[200:203], a[168:171], v[48:51]
    v_exp_f32 v34, v34
    v_mfma_f32_16x16x32_bf16 v[56:59], a[200:203], a[184:187], v[56:59]
    v_exp_f32 v35, v35
    v_mfma_f32_16x16x32_bf16 v[52:55], a[216:219], a[168:171], v[52:55]
    v_cvt_pk_bf16_f32 v65, v34, v35
    v_mfma_f32_16x16x32_bf16 v[60:63], a[216:219], a[184:187], v[60:63]
    v_exp_f32 v36, v36
    v_mfma_f32_16x16x32_bf16 v[48:51], a[204:207], a[172:175], v[48:51]
    v_exp_f32 v37, v37
    v_mfma_f32_16x16x32_bf16 v[56:59], a[204:207], a[188:191], v[56:59]
    v_cvt_pk_bf16_f32 v66, v36, v37
    v_mfma_f32_16x16x32_bf16 v[52:55], a[220:223], a[172:175], v[52:55]
    v_exp_f32 v38, v38
    v_mfma_f32_16x16x32_bf16 v[60:63], a[220:223], a[188:191], v[60:63]
    v_exp_f32 v39, v39
    buffer_load_dwordx4 a[192:195], v4, s[48:51], s52 offen offset:0 sc1
    v_cvt_pk_bf16_f32 v67, v38, v39
    buffer_load_dwordx4 a[208:211], v5, s[48:51], s52 offen offset:0 sc1
    v_exp_f32 v40, v40
    buffer_load_dwordx4 a[196:199], v4, s[48:51], s52 offen offset:1024 sc1
    v_exp_f32 v41, v41
    buffer_load_dwordx4 a[212:215], v5, s[48:51], s52 offen offset:1024 sc1
    v_cvt_pk_bf16_f32 v68, v40, v41
    buffer_load_dwordx4 a[200:203], v4, s[48:51], s52 offen offset:2048 sc1
    v_exp_f32 v42, v42
    buffer_load_dwordx4 a[216:219], v5, s[48:51], s52 offen offset:2048 sc1
    v_exp_f32 v43, v43
    buffer_load_dwordx4 a[204:207], v4, s[48:51], s52 offen offset:3072 sc1
    v_cvt_pk_bf16_f32 v69, v42, v43
    buffer_load_dwordx4 a[220:223], v5, s[48:51], s52 offen offset:3072 sc1
    v_exp_f32 v44, v44
    s_add_u32 s52, s52, 16384
    v_exp_f32 v45, v45
    s_nop 0
    v_cvt_pk_bf16_f32 v70, v44, v45
    v_exp_f32 v46, v46
    s_nop 0
    v_exp_f32 v47, v47
    s_nop 0
    v_cvt_pk_bf16_f32 v71, v46, v47
    v_exp_f32 v48, v48
    s_nop 0
    v_exp_f32 v49, v49
    s_nop 0
    v_cvt_pk_bf16_f32 v72, v48, v49
    v_exp_f32 v50, v50
    s_nop 0
    v_exp_f32 v51, v51
    s_nop 0
    v_cvt_pk_bf16_f32 v73, v50, v51
    v_exp_f32 v52, v52
    s_nop 0
    v_exp_f32 v53, v53
    s_nop 0
    v_cvt_pk_bf16_f32 v74, v52, v53
    v_exp_f32 v54, v54
    s_nop 0
    v_exp_f32 v55, v55
    s_nop 0
    s_mov_b32 s54, 0
    s_branch M_entry
M_loop:
    s_waitcnt vmcnt(17)
    v_mfma_f32_16x16x32_bf16 v[32:35], a[192:195], a[128:131], 0
    v_cvt_pk_bf16_f32 v123, v54, v55
    v_mfma_f32_16x16x32_bf16 v[40:43], a[192:195], a[144:147], 0
    buffer_load_dwordx4 v[128:131], v6, s[48:51], s53 offen offset:0 sc1
    v_mfma_f32_16x16x32_bf16 v[36:39], a[208:211], a[128:131], 0
    v_exp_f32 v56, v56
    v_mfma_f32_16x16x32_bf16 v[44:47], a[208:211], a[144:147], 0
    v_exp_f32 v57, v57
    v_mfma_f32_16x16x32_bf16 v[32:35], a[196:199], a[132:135], v[32:35]
    v_cvt_pk_bf16_f32 v124, v56, v57
    v_mfma_f32_16x16x32_bf16 v[40:43], a[196:199], a[148:151], v[40:43]
    buffer_load_dwordx4 v[132:135], v6, s[48:51], s53 offen offset:1024 sc1
    v_mfma_f32_16x16x32_bf16 v[36:39], a[212:215], a[132:135], v[36:39]
    v_exp_f32 v58, v58
    v_mfma_f32_16x16x32_bf16 v[44:47], a[212:215], a[148:151], v[44:47]
    v_exp_f32 v59, v59
    v_mfma_f32_16x16x32_bf16 v[32:35], a[200:203], a[136:139], v[32:35]
    v_cvt_pk_bf16_f32 v125, v58, v59
    v_mfma_f32_16x16x32_bf16 v[40:43], a[200:203], a[152:155], v[40:43]
    buffer_load_dwordx4 v[136:139], v6, s[48:51], s53 offen offset:2048 sc1
    v_mfma_f32_16x16x32_bf16 v[36:39], a[216:219], a[136:139], v[36:39]
    v_exp_f32 v60, v60
    v_mfma_f32_16x16x32_bf16 v[44:47], a[216:219], a[152:155], v[44:47]
    v_exp_f32 v61, v61
    v_mfma_f32_16x16x32_bf16 v[32:35], a[204:207], a[140:143], v[32:35]
    v_cvt_pk_bf16_f32 v126, v60, v61
    v_mfma_f32_16x16x32_bf16 v[40:43], a[204:207], a[156:159], v[40:43]
    buffer_load_dwordx4 v[140:143], v6, s[48:51], s53 offen offset:3072 sc1
    v_mfma_f32_16x16x32_bf16 v[36:39], a[220:223], a[140:143], v[36:39]
    v_exp_f32 v62, v62
    v_mfma_f32_16x16x32_bf16 v[44:47], a[220:223], a[156:159], v[44:47]
    v_exp_f32 v63, v63
    s_waitcnt vmcnt(12)
    v_mfma_f32_16x16x32_bf16 a[0:3], v[160:163], v[112:115], a[0:3]
    v_cvt_pk_bf16_f32 v127, v62, v63
    v_mfma_f32_16x16x32_bf16 a[32:35], v[160:163], v[116:119], a[32:35]
    buffer_load_dwordx4 v[144:147], v7, s[48:51], s53 offen offset:0 sc1
    v_mfma_f32_16x16x32_bf16 a[4:7], v[164:167], v[112:115], a[4:7]
    v_cmp_eq_u64 vcc, v[84:85], s[46:47]
    v_mfma_f32_16x16x32_bf16 a[36:39], v[164:167], v[116:119], a[36:39]
    v_mfma_f32_16x16x32_bf16 a[8:11], v[168:171], v[112:115], a[8:11]
    v_exp_f32 v32, v32
    v_mfma_f32_16x16x32_bf16 a[40:43], v[168:171], v[116:119], a[40:43]
    v_exp_f32 v33, v33
    s_lshr_b32 s58, vcc_lo, 1
    s_and_b32 s58, s58, vcc_lo
    v_mfma_f32_16x16x32_bf16 a[12:15], v[172:175], v[112:115], a[12:15]
    v_cvt_pk_bf16_f32 v64, v32, v33
    v_mfma_f32_16x16x32_bf16 a[44:47], v[172:175], v[116:119], a[44:47]
    buffer_load_dwordx4 v[148:151], v7, s[48:51], s53 offen offset:1024 sc1
    v_mfma_f32_16x16x32_bf16 a[16:19], v[176:179], v[112:115], a[16:19]
    v_exp_f32 v34, v34
    v_mfma_f32_16x16x32_bf16 a[48:51], v[176:179], v[116:119], a[48:51]
    v_exp_f32 v35, v35
    s_lshr_b32 s59, s58, 2
    s_and_b32 s58, s58, s59
    v_mfma_f32_16x16x32_bf16 a[20:23], v[180:183], v[112:115], a[20:23]
    v_cvt_pk_bf16_f32 v65, v34, v35
    v_mfma_f32_16x16x32_bf16 a[52:55], v[180:183], v[116:119], a[52:55]
    buffer_load_dwordx4 v[152:155], v7, s[48:51], s53 offen offset:2048 sc1
    v_mfma_f32_16x16x32_bf16 a[24:27], v[184:187], v[112:115], a[24:27]
    v_exp_f32 v36, v36
    v_mfma_f32_16x16x32_bf16 a[56:59], v[184:187], v[116:119], a[56:59]
    v_exp_f32 v37, v37
    s_and_b32 s58, s58, 0x11111111
    v_mfma_f32_16x16x32_bf16 a[28:31], v[188:191], v[112:115], a[28:31]
    v_cvt_pk_bf16_f32 v66, v36, v37
    v_mfma_f32_16x16x32_bf16 a[60:63], v[188:191], v[116:119], a[60:63]
    buffer_load_dwordx4 v[156:159], v7, s[48:51], s53 offen offset:3072 sc1
    v_mfma_f32_16x16x32_bf16 v[96:99], v[88:91], v[112:115], v[96:99]
    v_exp_f32 v38, v38
    s_add_u32 s53, s53, 16384
    v_mfma_f32_16x16x32_bf16 v[100:103], v[88:91], v[116:119], v[100:103]
    v_exp_f32 v39, v39
    v_mfma_f32_16x16x32_bf16 v[48:51], a[192:195], a[160:163], 0
    v_cvt_pk_bf16_f32 v67, v38, v39
    v_mfma_f32_16x16x32_bf16 v[56:59], a[192:195], a[176:179], 0
    s_andn2_b32 s58, s58, s55
    s_cbranch_scc0 M_slowpoll
    s_ff1_i32_b32 s59, s58
    s_bitset1_b32 s55, s59
    s_add_u32 s59, s59, s1
    s_and_b32 s59, s59, 31
    s_lshl_b32 s101, s59, 13
M_pollret:
    s_mov_b32 s52, s101
    v_mfma_f32_16x16x32_bf16 v[52:55], a[208:211], a[160:163], 0
    v_exp_f32 v40, v40
    v_mfma_f32_16x16x32_bf16 v[60:63], a[208:211], a[176:179], 0
    v_exp_f32 v41, v41
    v_mfma_f32_16x16x32_bf16 v[48:51], a[196:199], a[164:167], v[48:51]
    v_cvt_pk_bf16_f32 v68, v40, v41
    v_mfma_f32_16x16x32_bf16 v[56:59], a[196:199], a[180:183], v[56:59]
    buffer_load_dwordx4 a[192:195], v4, s[48:51], s52 offen offset:0 sc1
    v_mfma_f32_16x16x32_bf16 v[52:55], a[212:215], a[164:167], v[52:55]
    v_exp_f32 v42, v42
    v_mfma_f32_16x16x32_bf16 v[60:63], a[212:215], a[180:183], v[60:63]
    v_exp_f32 v43, v43
    v_mfma_f32_16x16x32_bf16 v[48:51], a[200:203], a[168:171], v[48:51]
    v_cvt_pk_bf16_f32 v69, v42, v43
    v_mfma_f32_16x16x32_bf16 v[56:59], a[200:203], a[184:187], v[56:59]
    buffer_load_dwordx4 a[208:211], v5, s[48:51], s52 offen offset:0 sc1
    v_mfma_f32_16x16x32_bf16 v[52:55], a[216:219], a[168:171], v[52:55]
    v_exp_f32 v44, v44
    v_mfma_f32_16x16x32_bf16 v[60:63], a[216:219], a[184:187], v[60:63]
    v_exp_f32 v45, v45
    v_mfma_f32_16x16x32_bf16 v[48:51], a[204:207], a[172:175], v[48:51]
    v_cvt_pk_bf16_f32 v70, v44, v45
    v_mfma_f32_16x16x32_bf16 v[56:59], a[204:207], a[188:191], v[56:59]
    buffer_load_dwordx4 a[196:199], v4, s[48:51], s52 offen offset:1024 sc1
    v_mfma_f32_16x16x32_bf16 v[52:55], a[220:223], a[172:175], v[52:55]
    v_exp_f32 v46, v46
    v_mfma_f32_16x16x32_bf16 v[60:63], a[220:223], a[188:191], v[60:63]
    v_exp_f32 v47, v47
    v_mfma_f32_16x16x32_bf16 a[64:67], v[160:163], v[120:123], a[64:67]
    v_cvt_pk_bf16_f32 v71, v46, v47
    v_mfma_f32_16x16x32_bf16 a[96:99], v[160:163], v[124:127], a[96:99]
    buffer_load_dwordx4 a[212:215], v5, s[48:51], s52 offen offset:1024 sc1
    v_mfma_f32_16x16x32_bf16 a[68:71], v[164:167], v[120:123], a[68:71]
    v_mfma_f32_16x16x32_bf16 a[100:103], v[164:167], v[124:127], a[100:103]
    buffer_load_dwordx4 a[200:203], v4, s[48:51], s52 offen offset:2048 sc1
    v_mfma_f32_16x16x32_bf16 a[72:75], v[168:171], v[120:123], a[72:75]
    v_exp_f32 v48, v48
    v_mfma_f32_16x16x32_bf16 a[104:107], v[168:171], v[124:127], a[104:107]
    v_exp_f32 v49, v49
    v_mfma_f32_16x16x32_bf16 a[76:79], v[172:175], v[120:123], a[76:79]
    v_cvt_pk_bf16_f32 v72, v48, v49
    v_mfma_f32_16x16x32_bf16 a[108:111], v[172:175], v[124:127], a[108:111]
    buffer_load_dwordx4 a[216:219], v5, s[48:51], s52 offen offset:2048 sc1
    v_mfma_f32_16x16x32_bf16 a[80:83], v[176:179], v[120:123], a[80:83]
    v_exp_f32 v50, v50
    v_mfma_f32_16x16x32_bf16 a[112:115], v[176:179], v[124:127], a[112:115]
    v_exp_f32 v51, v51
    v_mfma_f32_16x16x32_bf16 a[84:87], v[180:183], v[120:123], a[84:87]
    v_cvt_pk_bf16_f32 v73, v50, v51
    v_mfma_f32_16x16x32_bf16 a[116:119], v[180:183], v[124:127], a[116:119]
    buffer_load_dwordx4 a[204:207], v4, s[48:51], s52 offen offset:3072 sc1
    v_mfma_f32_16x16x32_bf16 a[88:91], v[184:187], v[120:123], a[88:91]
    v_exp_f32 v52, v52
    v_mfma_f32_16x16x32_bf16 a[120:123], v[184:187], v[124:127], a[120:123]
    v_exp_f32 v53, v53
    v_mfma_f32_16x16x32_bf16 a[92:95], v[188:191], v[120:123], a[92:95]
    v_cvt_pk_bf16_f32 v74, v52, v53
    v_mfma_f32_16x16x32_bf16 a[124:127], v[188:191], v[124:127], a[124:127]
    buffer_load_dwordx4 a[220:223], v5, s[48:51], s52 offen offset:3072 sc1
    v_mfma_f32_16x16x32_bf16 v[104:107], v[88:91], v[120:123], v[104:107]
    v_exp_f32 v54, v54
    s_add_u32 s52, s52, 16384
    v_mfma_f32_16x16x32_bf16 v[108:111], v[88:91], v[124:127], v[108:111]
    v_exp_f32 v55, v55
M_entry:
    s_waitcnt vmcnt(16)
    v_mfma_f32_16x16x32_bf16 v[32:35], a[224:227], a[128:131], 0
    v_cvt_pk_bf16_f32 v75, v54, v55
    v_mfma_f32_16x16x32_bf16 v[40:43], a[224:227], a[144:147], 0
    buffer_load_dwordx4 v[160:163], v6, s[48:51], s53 offen offset:0 sc1
    v_mfma_f32_16x16x32_bf16 v[36:39], a[240:243], a[128:131], 0
    v_exp_f32 v56, v56
    v_mfma_f32_16x16x32_bf16 v[44:47], a[240:243], a[144:147], 0
    v_exp_f32 v57, v57
    v_mfma_f32_16x16x32_bf16 v[32:35], a[228:231], a[132:135], v[32:35]
    v_cvt_pk_bf16_f32 v76, v56, v57
    v_mfma_f32_16x16x32_bf16 v[40:43], a[228:231], a[148:151], v[40:43]
    buffer_load_dwordx4 v[164:167], v6, s[48:51], s53 offen offset:1024 sc1
    v_mfma_f32_16x16x32_bf16 v[36:39], a[244:247], a[132:135], v[36:39]
    v_exp_f32 v58, v58
    v_mfma_f32_16x16x32_bf16 v[44:47], a[244:247], a[148:151], v[44:47]
    v_exp_f32 v59, v59
    v_mfma_f32_16x16x32_bf16 v[32:35], a[232:235], a[136:139], v[32:35]
    v_cvt_pk_bf16_f32 v77, v58, v59
    v_mfma_f32_16x16x32_bf16 v[40:43], a[232:235], a[152:155], v[40:43]
    buffer_load_dwordx4 v[168:171], v6, s[48:51], s53 offen offset:2048 sc1
    v_mfma_f32_16x16x32_bf16 v[36:39], a[248:251], a[136:139], v[36:39]
    v_exp_f32 v60, v60
    v_mfma_f32_16x16x32_bf16 v[44:47], a[248:251], a[152:155], v[44:47]
    v_exp_f32 v61, v61
    v_mfma_f32_16x16x32_bf16 v[32:35], a[236:239], a[140:143], v[32:35]
    v_cvt_pk_bf16_f32 v78, v60, v61
    v_mfma_f32_16x16x32_bf16 v[40:43], a[236:239], a[156:159], v[40:43]
    buffer_load_dwordx4 v[172:175], v6, s[48:51], s53 offen offset:3072 sc1
    v_mfma_f32_16x16x32_bf16 v[36:39], a[252:255], a[140:143], v[36:39]
    v_exp_f32 v62, v62
    v_mfma_f32_16x16x32_bf16 v[44:47], a[252:255], a[156:159], v[44:47]
    v_exp_f32 v63, v63
    s_waitcnt vmcnt(12)
    v_mfma_f32_16x16x32_bf16 a[0:3], v[128:131], v[64:67], a[0:3]
    v_cvt_pk_bf16_f32 v79, v62, v63
    v_mfma_f32_16x16x32_bf16 a[32:35], v[128:131], v[68:71], a[32:35]
    buffer_load_dwordx4 v[176:179], v7, s[48:51], s53 offen offset:0 sc1
    s_cmp_lg_u32 s3, 0
    s_cbranch_scc1 M_pend
M_pendret:
    v_mfma_f32_16x16x32_bf16 a[4:7], v[132:135], v[64:67], a[4:7]
    v_mfma_f32_16x16x32_bf16 a[36:39], v[132:135], v[68:71], a[36:39]
    v_mfma_f32_16x16x32_bf16 a[8:11], v[136:139], v[64:67], a[8:11]
    v_exp_f32 v32, v32
    v_mfma_f32_16x16x32_bf16 a[40:43], v[136:139], v[68:71], a[40:43]
    v_exp_f32 v33, v33
    v_mfma_f32_16x16x32_bf16 a[12:15], v[140:143], v[64:67], a[12:15]
    v_cvt_pk_bf16_f32 v112, v32, v33
    v_mfma_f32_16x16x32_bf16 a[44:47], v[140:143], v[68:71], a[44:47]
    buffer_load_dwordx4 v[180:183], v7, s[48:51], s53 offen offset:1024 sc1
    v_mfma_f32_16x16x32_bf16 a[16:19], v[144:147], v[64:67], a[16:19]
    v_exp_f32 v34, v34
    v_mfma_f32_16x16x32_bf16 a[48:51], v[144:147], v[68:71], a[48:51]
    v_exp_f32 v35, v35
    v_mfma_f32_16x16x32_bf16 a[20:23], v[148:151], v[64:67], a[20:23]
    v_cvt_pk_bf16_f32 v113, v34, v35
    v_mfma_f32_16x16x32_bf16 a[52:55], v[148:151], v[68:71], a[52:55]
    buffer_load_dwordx4 v[184:187], v7, s[48:51], s53 offen offset:2048 sc1
    v_mfma_f32_16x16x32_bf16 a[24:27], v[152:155], v[64:67], a[24:27]
    v_exp_f32 v36, v36
    v_mfma_f32_16x16x32_bf16 a[56:59], v[152:155], v[68:71], a[56:59]
    v_exp_f32 v37, v37
    v_mfma_f32_16x16x32_bf16 a[28:31], v[156:159], v[64:67], a[28:31]
    v_cvt_pk_bf16_f32 v114, v36, v37
    v_mfma_f32_16x16x32_bf16 a[60:63], v[156:159], v[68:71], a[60:63]
    buffer_load_dwordx4 v[188:191], v7, s[48:51], s53 offen offset:3072 sc1
    v_mfma_f32_16x16x32_bf16 v[96:99], v[88:91], v[64:67], v[96:99]
    v_exp_f32 v38, v38
    s_mov_b32 s53, s101
    v_mfma_f32_16x16x32_bf16 v[100:103], v[88:91], v[68:71], v[100:103]
    v_exp_f32 v39, v39
    v_mfma_f32_16x16x32_bf16 v[48:51], a[224:227], a[160:163], 0
    v_cvt_pk_bf16_f32 v115, v38, v39
    v_mfma_f32_16x16x32_bf16 v[56:59], a[224:227], a[176:179], 0
    global_load_dwordx2 v[84:85], v30, s[56:57] sc1
    v_mfma_f32_16x16x32_bf16 v[52:55], a[240:243], a[160:163], 0
    v_exp_f32 v40, v40
    v_mfma_f32_16x16x32_bf16 v[60:63], a[240:243], a[176:179], 0
    v_exp_f32 v41, v41
    v_mfma_f32_16x16x32_bf16 v[48:51], a[228:231], a[164:167], v[48:51]
    v_cvt_pk_bf16_f32 v116, v40, v41
    v_mfma_f32_16x16x32_bf16 v[56:59], a[228:231], a[180:183], v[56:59]
    buffer_load_dwordx4 a[224:227], v4, s[48:51], s52 offen offset:0 sc1
    v_mfma_f32_16x16x32_bf16 v[52:55], a[244:247], a[164:167], v[52:55]
    v_exp_f32 v42, v42
    v_mfma_f32_16x16x32_bf16 v[60:63], a[244:247], a[180:183], v[60:63]
    v_exp_f32 v43, v43
    v_mfma_f32_16x16x32_bf16 v[48:51], a[232:235], a[168:171], v[48:51]
    v_cvt_pk_bf16_f32 v117, v42, v43
    v_mfma_f32_16x16x32_bf16 v[56:59], a[232:235], a[184:187], v[56:59]
    buffer_load_dwordx4 a[240:243], v5, s[48:51], s52 offen offset:0 sc1
    v_mfma_f32_16x16x32_bf16 v[52:55], a[248:251], a[168:171], v[52:55]
    v_exp_f32 v44, v44
    v_mfma_f32_16x16x32_bf16 v[60:63], a[248:251], a[184:187], v[60:63]
    v_exp_f32 v45, v45
    v_mfma_f32_16x16x32_bf16 v[48:51], a[236:239], a[172:175], v[48:51]
    v_cvt_pk_bf16_f32 v118, v44, v45
    v_mfma_f32_16x16x32_bf16 v[56:59], a[236:239], a[188:191], v[56:59]
    buffer_load_dwordx4 a[228:231], v4, s[48:51], s52 offen offset:1024 sc1
    v_mfma_f32_16x16x32_bf16 v[52:55], a[252:255], a[172:175], v[52:55]
    v_exp_f32 v46, v46
    v_mfma_f32_16x16x32_bf16 v[60:63], a[252:255], a[188:191], v[60:63]
    v_exp_f32 v47, v47
    v_mfma_f32_16x16x32_bf16 a[64:67], v[128:131], v[72:75], a[64:67]
    v_cvt_pk_bf16_f32 v119, v46, v47
    v_mfma_f32_16x16x32_bf16 a[96:99], v[128:131], v[76:79], a[96:99]
    buffer_load_dwordx4 a[244:247], v5, s[48:51], s52 offen offset:1024 sc1
    v_mfma_f32_16x16x32_bf16 a[68:71], v[132:135], v[72:75], a[68:71]
    v_mfma_f32_16x16x32_bf16 a[100:103], v[132:135], v[76:79], a[100:103]
    buffer_load_dwordx4 a[232:235], v4, s[48:51], s52 offen offset:2048 sc1
    v_mfma_f32_16x16x32_bf16 a[72:75], v[136:139], v[72:75], a[72:75]
    v_exp_f32 v48, v48
    v_mfma_f32_16x16x32_bf16 a[104:107], v[136:139], v[76:79], a[104:107]
    v_exp_f32 v49, v49
    v_mfma_f32_16x16x32_bf16 a[76:79], v[140:143], v[72:75], a[76:79]
    v_cvt_pk_bf16_f32 v120, v48, v49
    v_mfma_f32_16x16x32_bf16 a[108:111], v[140:143], v[76:79], a[108:111]
    buffer_load_dwordx4 a[248:251], v5, s[48:51], s52 offen offset:2048 sc1
    v_mfma_f32_16x16x32_bf16 a[80:83], v[144:147], v[72:75], a[80:83]
    v_exp_f32 v50, v50
    v_mfma_f32_16x16x32_bf16 a[112:115], v[144:147], v[76:79], a[112:115]
    v_exp_f32 v51, v51
    v_mfma_f32_16x16x32_bf16 a[84:87], v[148:151], v[72:75], a[84:87]
    v_cvt_pk_bf16_f32 v121, v50, v51
    v_mfma_f32_16x16x32_bf16 a[116:119], v[148:151], v[76:79], a[116:119]
    buffer_load_dwordx4 a[236:239], v4, s[48:51], s52 offen offset:3072 sc1
    v_mfma_f32_16x16x32_bf16 a[88:91], v[152:155], v[72:75], a[88:91]
    v_exp_f32 v52, v52
    v_mfma_f32_16x16x32_bf16 a[120:123], v[152:155], v[76:79], a[120:123]
    v_exp_f32 v53, v53
    v_mfma_f32_16x16x32_bf16 a[92:95], v[156:159], v[72:75], a[92:95]
    v_cvt_pk_bf16_f32 v122, v52, v53
    v_mfma_f32_16x16x32_bf16 a[124:127], v[156:159], v[76:79], a[124:127]
    buffer_load_dwordx4 a[252:255], v5, s[48:51], s52 offen offset:3072 sc1
    v_mfma_f32_16x16x32_bf16 v[104:107], v[88:91], v[72:75], v[104:107]
    v_exp_f32 v54, v54
    v_mfma_f32_16x16x32_bf16 v[108:111], v[88:91], v[76:79], v[108:111]
    v_exp_f32 v55, v55
    s_add_u32 s54, s54, 1
    s_cmp_lt_u32 s54, 8
    s_cbranch_scc1 M_loop
    s_nop 0
    v_cvt_pk_bf16_f32 v123, v54, v55
    s_nop 0
    s_nop 0
    v_exp_f32 v56, v56
    s_nop 0
    v_exp_f32 v57, v57
    s_nop 0
    v_cvt_pk_bf16_f32 v124, v56, v57
    s_nop 0
    s_nop 0
    v_exp_f32 v58, v58
    s_nop 0
    v_exp_f32 v59, v59
    s_nop 0
    v_cvt_pk_bf16_f32 v125, v58, v59
    s_nop 0
    s_nop 0
    v_exp_f32 v60, v60
    s_nop 0
    v_exp_f32 v61, v61
    s_nop 0
    v_cvt_pk_bf16_f32 v126, v60, v61
    s_nop 0
    s_nop 0
    v_exp_f32 v62, v62
    s_nop 0
    v_exp_f32 v63, v63
    s_waitcnt vmcnt(0)
    v_mfma_f32_16x16x32_bf16 a[0:3], v[160:163], v[112:115], a[0:3]
    v_cvt_pk_bf16_f32 v127, v62, v63
    v_mfma_f32_16x16x32_bf16 a[32:35], v[160:163], v[116:119], a[32:35]
    s_nop 1
    v_mfma_f32_16x16x32_bf16 a[4:7], v[164:167], v[112:115], a[4:7]
    v_mfma_f32_16x16x32_bf16 a[36:39], v[164:167], v[116:119], a[36:39]
    v_mfma_f32_16x16x32_bf16 a[8:11], v[168:171], v[112:115], a[8:11]
    v_mfma_f32_16x16x32_bf16 a[40:43], v[168:171], v[116:119], a[40:43]
    v_mfma_f32_16x16x32_bf16 a[12:15], v[172:175], v[112:115], a[12:15]
    v_mfma_f32_16x16x32_bf16 a[44:47], v[172:175], v[116:119], a[44:47]
    v_mfma_f32_16x16x32_bf16 a[16:19], v[176:179], v[112:115], a[16:19]
    v_mfma_f32_16x16x32_bf16 a[48:51], v[176:179], v[116:119], a[48:51]
    v_mfma_f32_16x16x32_bf16 a[20:23], v[180:183], v[112:115], a[20:23]
    v_mfma_f32_16x16x32_bf16 a[52:55], v[180:183], v[116:119], a[52:55]
    v_mfma_f32_16x16x32_bf16 a[24:27], v[184:187], v[112:115], a[24:27]
    v_mfma_f32_16x16x32_bf16 a[56:59], v[184:187], v[116:119], a[56:59]
    v_mfma_f32_16x16x32_bf16 a[28:31], v[188:191], v[112:115], a[28:31]
    v_mfma_f32_16x16x32_bf16 a[60:63], v[188:191], v[116:119], a[60:63]
    v_mfma_f32_16x16x32_bf16 v[96:99], v[88:91], v[112:115], v[96:99]
    v_mfma_f32_16x16x32_bf16 v[100:103], v[88:91], v[116:119], v[100:103]
    s_mov_b32 s15, 0
    s_cmp_eq_u32 s6, 0
    s_cbranch_scc1 M_fin0
    s_cmp_eq_u32 s6, 1
    s_cbranch_scc1 M_fin1
    s_cmp_eq_u32 s6, 2
    s_cbranch_scc1 M_fin2
M_fin3:
    v_mfma_f32_16x16x32_bf16 a[64:67], v[160:163], v[120:123], a[64:67]
    v_mfma_f32_16x16x32_bf16 a[96:99], v[160:163], v[124:127], a[96:99]
    ds_write_b128 v8, a[0:3] offset:0
    v_mfma_f32_16x16x32_bf16 a[68:71], v[164:167], v[120:123], a[68:71]
    ds_write_b128 v8, a[32:35] offset:32768
    v_mfma_f32_16x16x32_bf16 a[100:103], v[164:167], v[124:127], a[100:103]
    ds_write_b128 v8, a[4:7] offset:1024
    v_mfma_f32_16x16x32_bf16 a[72:75], v[168:171], v[120:123], a[72:75]
    ds_write_b128 v8, a[36:39] offset:33792
    v_mfma_f32_16x16x32_bf16 a[104:107], v[168:171], v[124:127], a[104:107]
    ds_write_b128 v8, a[8:11] offset:2048
    v_mfma_f32_16x16x32_bf16 a[76:79], v[172:175], v[120:123], a[76:79]
    ds_write_b128 v8, a[40:43] offset:34816
    v_mfma_f32_16x16x32_bf16 a[108:111], v[172:175], v[124:127], a[108:111]
    ds_write_b128 v8, a[12:15] offset:3072
    v_mfma_f32_16x16x32_bf16 a[80:83], v[176:179], v[120:123], a[80:83]
    ds_write_b128 v8, a[44:47] offset:35840
    v_mfma_f32_16x16x32_bf16 a[112:115], v[176:179], v[124:127], a[112:115]
    ds_write_b128 v8, a[16:19] offset:4096
    v_mfma_f32_16x16x32_bf16 a[84:87], v[180:183], v[120:123], a[84:87]
    ds_write_b128 v8, a[48:51] offset:36864
    v_mfma_f32_16x16x32_bf16 a[116:119], v[180:183], v[124:127], a[116:119]
    ds_write_b128 v8, a[20:23] offset:5120
    v_mfma_f32_16x16x32_bf16 a[88:91], v[184:187], v[120:123], a[88:91]
    ds_write_b128 v8, a[52:55] offset:37888
    v_mfma_f32_16x16x32_bf16 a[120:123], v[184:187], v[124:127], a[120:123]
    ds_write_b128 v8, a[24:27] offset:6144
    v_mfma_f32_16x16x32_bf16 a[92:95], v[188:191], v[120:123], a[92:95]
    ds_write_b128 v8, a[56:59] offset:38912
    v_mfma_f32_16x16x32_bf16 a[124:127], v[188:191], v[124:127], a[124:127]
    ds_write_b128 v8, a[28:31] offset:7168
    v_mfma_f32_16x16x32_bf16 v[104:107], v[88:91], v[120:123], v[104:107]
    ds_write_b128 v8, a[60:63] offset:39936
    v_mfma_f32_16x16x32_bf16 v[108:111], v[88:91], v[124:127], v[108:111]
    s_nop 8
    ds_write_b128 v9, a[64:67] offset:0
    v_accvgpr_read_b32 v32, a96
    v_accvgpr_read_b32 v33, a97
    v_accvgpr_read_b32 v34, a98
    ds_write_b128 v9, a[68:71] offset:1024
    v_accvgpr_read_b32 v35, a99
    v_accvgpr_read_b32 v36, a100
    v_accvgpr_read_b32 v37, a101
    ds_write_b128 v9, a[72:75] offset:2048
    v_accvgpr_read_b32 v38, a102
    v_accvgpr_read_b32 v39, a103
    v_accvgpr_read_b32 v40, a104
    ds_write_b128 v9, a[76:79] offset:3072
    v_accvgpr_read_b32 v41, a105
    v_accvgpr_read_b32 v42, a106
    v_accvgpr_read_b32 v43, a107
    ds_write_b128 v9, a[80:83] offset:4096
    v_accvgpr_read_b32 v44, a108
    v_accvgpr_read_b32 v45, a109
    v_accvgpr_read_b32 v46, a110
    ds_write_b128 v9, a[84:87] offset:5120
    v_accvgpr_read_b32 v47, a111
    v_accvgpr_read_b32 v48, a112
    v_accvgpr_read_b32 v49, a113
    ds_write_b128 v9, a[88:91] offset:6144
    v_accvgpr_read_b32 v50, a114
    v_accvgpr_read_b32 v51, a115
    v_accvgpr_read_b32 v52, a116
    ds_write_b128 v9, a[92:95] offset:7168
    v_accvgpr_read_b32 v53, a117
    v_accvgpr_read_b32 v54, a118
    v_accvgpr_read_b32 v55, a119
    v_accvgpr_read_b32 v56, a120
    v_accvgpr_read_b32 v57, a121
    v_accvgpr_read_b32 v58, a122
    v_accvgpr_read_b32 v59, a123
    v_accvgpr_read_b32 v60, a124
    v_accvgpr_read_b32 v61, a125
    v_accvgpr_read_b32 v62, a126
    v_accvgpr_read_b32 v63, a127
    ds_write_b32 v11, v96 offset:0
    ds_write_b32 v11, v100 offset:256
    ds_write_b32 v11, v104 offset:512
    ds_write_b32 v11, v108 offset:768
    s_branch M_xbar
M_fin0:
    v_mfma_f32_16x16x32_bf16 a[64:67], v[160:163], v[120:123], a[64:67]
    v_mfma_f32_16x16x32_bf16 a[96:99], v[160:163], v[124:127], a[96:99]
    ds_write_b128 v8, a[32:35] offset:32768
    v_mfma_f32_16x16x32_bf16 a[68:71], v[164:167], v[120:123], a[68:71]
    ds_write_b128 v8, a[36:39] offset:33792
    v_mfma_f32_16x16x32_bf16 a[100:103], v[164:167], v[124:127], a[100:103]
    ds_write_b128 v8, a[40:43] offset:34816
    v_mfma_f32_16x16x32_bf16 a[72:75], v[168:171], v[120:123], a[72:75]
    ds_write_b128 v8, a[44:47] offset:35840
    v_mfma_f32_16x16x32_bf16 a[104:107], v[168:171], v[124:127], a[104:107]
    ds_write_b128 v8, a[48:51] offset:36864
    v_mfma_f32_16x16x32_bf16 a[76:79], v[172:175], v[120:123], a[76:79]
    ds_write_b128 v8, a[52:55] offset:37888
    v_mfma_f32_16x16x32_bf16 a[108:111], v[172:175], v[124:127], a[108:111]
    ds_write_b128 v8, a[56:59] offset:38912
    v_mfma_f32_16x16x32_bf16 a[80:83], v[176:179], v[120:123], a[80:83]
    ds_write_b128 v8, a[60:63] offset:39936
    v_mfma_f32_16x16x32_bf16 a[112:115], v[176:179], v[124:127], a[112:115]
    v_accvgpr_read_b32 v32, a0
    v_mfma_f32_16x16x32_bf16 a[84:87], v[180:183], v[120:123], a[84:87]
    v_accvgpr_read_b32 v33, a1
    v_mfma_f32_16x16x32_bf16 a[116:119], v[180:183], v[124:127], a[116:119]
    v_accvgpr_read_b32 v34, a2
    v_mfma_f32_16x16x32_bf16 a[88:91], v[184:187], v[120:123], a[88:91]
    v_accvgpr_read_b32 v35, a3
    v_mfma_f32_16x16x32_bf16 a[120:123], v[184:187], v[124:127], a[120:123]
    v_accvgpr_read_b32 v36, a4
    v_mfma_f32_16x16x32_bf16 a[92:95], v[188:191], v[120:123], a[92:95]
    v_accvgpr_read_b32 v37, a5
    v_mfma_f32_16x16x32_bf16 a[124:127], v[188:191], v[124:127], a[124:127]
    v_accvgpr_read_b32 v38, a6
    v_mfma_f32_16x16x32_bf16 v[104:107], v[88:91], v[120:123], v[104:107]
    v_accvgpr_read_b32 v39, a7
    v_mfma_f32_16x16x32_bf16 v[108:111], v[88:91], v[124:127], v[108:111]
    v_accvgpr_read_b32 v40, a8
    v_accvgpr_read_b32 v41, a9
    v_accvgpr_read_b32 v42, a10
    v_accvgpr_read_b32 v43, a11
    v_accvgpr_read_b32 v44, a12
    v_accvgpr_read_b32 v45, a13
    v_accvgpr_read_b32 v46, a14
    v_accvgpr_read_b32 v47, a15
    v_accvgpr_read_b32 v48, a16
    v_accvgpr_read_b32 v49, a17
    v_accvgpr_read_b32 v50, a18
    ds_write_b128 v9, a[64:67] offset:0
    v_accvgpr_read_b32 v51, a19
    v_accvgpr_read_b32 v52, a20
    v_accvgpr_read_b32 v53, a21
    ds_write_b128 v9, a[96:99] offset:32768
    v_accvgpr_read_b32 v54, a22
    v_accvgpr_read_b32 v55, a23
    v_accvgpr_read_b32 v56, a24
    ds_write_b128 v9, a[68:71] offset:1024
    v_accvgpr_read_b32 v57, a25
    v_accvgpr_read_b32 v58, a26
    v_accvgpr_read_b32 v59, a27
    ds_write_b128 v9, a[100:103] offset:33792
    v_accvgpr_read_b32 v60, a28
    v_accvgpr_read_b32 v61, a29
    v_accvgpr_read_b32 v62, a30
    ds_write_b128 v9, a[72:75] offset:2048
    v_accvgpr_read_b32 v63, a31
    ds_write_b128 v9, a[104:107] offset:34816
    ds_write_b128 v9, a[76:79] offset:3072
    ds_write_b128 v9, a[108:111] offset:35840
    ds_write_b128 v9, a[80:83] offset:4096
    ds_write_b128 v9, a[112:115] offset:36864
    ds_write_b128 v9, a[84:87] offset:5120
    ds_write_b128 v9, a[116:119] offset:37888
    ds_write_b128 v9, a[88:91] offset:6144
    ds_write_b128 v9, a[120:123] offset:38912
    ds_write_b128 v9, a[92:95] offset:7168
    ds_write_b128 v9, a[124:127] offset:39936
    ds_write_b32 v11, v96 offset:0
    ds_write_b32 v11, v100 offset:256
    ds_write_b32 v11, v104 offset:512
    ds_write_b32 v11, v108 offset:768
    s_branch M_xbar
M_fin1:
    v_mfma_f32_16x16x32_bf16 a[64:67], v[160:163], v[120:123], a[64:67]
    v_mfma_f32_16x16x32_bf16 a[96:99], v[160:163], v[124:127], a[96:99]
    ds_write_b128 v8, a[0:3] offset:0
    v_mfma_f32_16x16x32_bf16 a[68:71], v[164:167], v[120:123], a[68:71]
    ds_write_b128 v8, a[4:7] offset:1024
    v_mfma_f32_16x16x32_bf16 a[100:103], v[164:167], v[124:127], a[100:103]
    ds_write_b128 v8, a[8:11] offset:2048
    v_mfma_f32_16x16x32_bf16 a[72:75], v[168:171], v[120:123], a[72:75]
    ds_write_b128 v8, a[12:15] offset:3072
    v_mfma_f32_16x16x32_bf16 a[104:107], v[168:171], v[124:127], a[104:107]
    ds_write_b128 v8, a[16:19] offset:4096
    v_mfma_f32_16x16x32_bf16 a[76:79], v[172:175], v[120:123], a[76:79]
    ds_write_b128 v8, a[20:23] offset:5120
    v_mfma_f32_16x16x32_bf16 a[108:111], v[172:175], v[124:127], a[108:111]
    ds_write_b128 v8, a[24:27] offset:6144
    v_mfma_f32_16x16x32_bf16 a[80:83], v[176:179], v[120:123], a[80:83]
    ds_write_b128 v8, a[28:31] offset:7168
    v_mfma_f32_16x16x32_bf16 a[112:115], v[176:179], v[124:127], a[112:115]
    v_accvgpr_read_b32 v32, a32
    v_mfma_f32_16x16x32_bf16 a[84:87], v[180:183], v[120:123], a[84:87]
    v_accvgpr_read_b32 v33, a33
    v_mfma_f32_16x16x32_bf16 a[116:119], v[180:183], v[124:127], a[116:119]
    v_accvgpr_read_b32 v34, a34
    v_mfma_f32_16x16x32_bf16 a[88:91], v[184:187], v[120:123], a[88:91]
    v_accvgpr_read_b32 v35, a35
    v_mfma_f32_16x16x32_bf16 a[120:123], v[184:187], v[124:127], a[120:123]
    v_accvgpr_read_b32 v36, a36
    v_mfma_f32_16x16x32_bf16 a[92:95], v[188:191], v[120:123], a[92:95]
    v_accvgpr_read_b32 v37, a37
    v_mfma_f32_16x16x32_bf16 a[124:127], v[188:191], v[124:127], a[124:127]
    v_accvgpr_read_b32 v38, a38
    v_mfma_f32_16x16x32_bf16 v[104:107], v[88:91], v[120:123], v[104:107]
    v_accvgpr_read_b32 v39, a39
    v_mfma_f32_16x16x32_bf16 v[108:111], v[88:91], v[124:127], v[108:111]
    v_accvgpr_read_b32 v40, a40
    v_accvgpr_read_b32 v41, a41
    v_accvgpr_read_b32 v42, a42
    v_accvgpr_read_b32 v43, a43
    v_accvgpr_read_b32 v44, a44
    v_accvgpr_read_b32 v45, a45
    v_accvgpr_read_b32 v46, a46
    v_accvgpr_read_b32 v47, a47
    v_accvgpr_read_b32 v48, a48
    v_accvgpr_read_b32 v49, a49
    v_accvgpr_read_b32 v50, a50
    ds_write_b128 v9, a[64:67] offset:0
    v_accvgpr_read_b32 v51, a51
    v_accvgpr_read_b32 v52, a52
    v_accvgpr_read_b32 v53, a53
    ds_write_b128 v9, a[96:99] offset:32768
    v_accvgpr_read_b32 v54, a54
    v_accvgpr_read_b32 v55, a55
    v_accvgpr_read_b32 v56, a56
    ds_write_b128 v9, a[68:71] offset:1024
    v_accvgpr_read_b32 v57, a57
    v_accvgpr_read_b32 v58, a58
    v_accvgpr_read_b32 v59, a59
    ds_write_b128 v9, a[100:103] offset:33792
    v_accvgpr_read_b32 v60, a60
    v_accvgpr_read_b32 v61, a61
    v_accvgpr_read_b32 v62, a62
    ds_write_b128 v9, a[72:75] offset:2048
    v_accvgpr_read_b32 v63, a63
    ds_write_b128 v9, a[104:107] offset:34816
    ds_write_b128 v9, a[76:79] offset:3072
    ds_write_b128 v9, a[108:111] offset:35840
    ds_write_b128 v9, a[80:83] offset:4096
    ds_write_b128 v9, a[112:115] offset:36864
    ds_write_b128 v9, a[84:87] offset:5120
    ds_write_b128 v9, a[116:119] offset:37888
    ds_write_b128 v9, a[88:91] offset:6144
    ds_write_b128 v9, a[120:123] offset:38912
    ds_write_b128 v9, a[92:95] offset:7168
    ds_write_b128 v9, a[124:127] offset:39936
    ds_write_b32 v11, v96 offset:0
    ds_write_b32 v11, v100 offset:256
    ds_write_b32 v11, v104 offset:512
    ds_write_b32 v11, v108 offset:768
    s_branch M_xbar
M_fin2:
    v_mfma_f32_16x16x32_bf16 a[64:67], v[160:163], v[120:123], a[64:67]
    v_mfma_f32_16x16x32_bf16 a[96:99], v[160:163], v[124:127], a[96:99]
    ds_write_b128 v8, a[0:3] offset:0
    v_mfma_f32_16x16x32_bf16 a[68:71], v[164:167], v[120:123], a[68:71]
    ds_write_b128 v8, a[32:35] offset:32768
    v_mfma_f32_16x16x32_bf16 a[100:103], v[164:167], v[124:127], a[100:103]
    ds_write_b128 v8, a[4:7] offset:1024
    v_mfma_f32_16x16x32_bf16 a[72:75], v[168:171], v[120:123], a[72:75]
    ds_write_b128 v8, a[36:39] offset:33792
    v_mfma_f32_16x16x32_bf16 a[104:107], v[168:171], v[124:127], a[104:107]
    ds_write_b128 v8, a[8:11] offset:2048
    v_mfma_f32_16x16x32_bf16 a[76:79], v[172:175], v[120:123], a[76:79]
    ds_write_b128 v8, a[40:43] offset:34816
    v_mfma_f32_16x16x32_bf16 a[108:111], v[172:175], v[124:127], a[108:111]
    ds_write_b128 v8, a[12:15] offset:3072
    v_mfma_f32_16x16x32_bf16 a[80:83], v[176:179], v[120:123], a[80:83]
    ds_write_b128 v8, a[44:47] offset:35840
    v_mfma_f32_16x16x32_bf16 a[112:115], v[176:179], v[124:127], a[112:115]
    ds_write_b128 v8, a[16:19] offset:4096
    v_mfma_f32_16x16x32_bf16 a[84:87], v[180:183], v[120:123], a[84:87]
    ds_write_b128 v8, a[48:51] offset:36864
    v_mfma_f32_16x16x32_bf16 a[116:119], v[180:183], v[124:127], a[116:119]
    ds_write_b128 v8, a[20:23] offset:5120
    v_mfma_f32_16x16x32_bf16 a[88:91], v[184:187], v[120:123], a[88:91]
    ds_write_b128 v8, a[52:55] offset:37888
    v_mfma_f32_16x16x32_bf16 a[120:123], v[184:187], v[124:127], a[120:123]
    ds_write_b128 v8, a[24:27] offset:6144
    v_mfma_f32_16x16x32_bf16 a[92:95], v[188:191], v[120:123], a[92:95]
    ds_write_b128 v8, a[56:59] offset:38912
    v_mfma_f32_16x16x32_bf16 a[124:127], v[188:191], v[124:127], a[124:127]
    ds_write_b128 v8, a[28:31] offset:7168
    v_mfma_f32_16x16x32_bf16 v[104:107], v[88:91], v[120:123], v[104:107]
    ds_write_b128 v8, a[60:63] offset:39936
    v_mfma_f32_16x16x32_bf16 v[108:111], v[88:91], v[124:127], v[108:111]
    s_nop 8
    ds_write_b128 v9, a[96:99] offset:32768
    v_accvgpr_read_b32 v32, a64
    v_accvgpr_read_b32 v33, a65
    v_accvgpr_read_b32 v34, a66
    ds_write_b128 v9, a[100:103] offset:33792
    v_accvgpr_read_b32 v35, a67
    v_accvgpr_read_b32 v36, a68
    v_accvgpr_read_b32 v37, a69
    ds_write_b128 v9, a[104:107] offset:34816
    v_accvgpr_read_b32 v38, a70
    v_accvgpr_read_b32 v39, a71
    v_accvgpr_read_b32 v40, a72
    ds_write_b128 v9, a[108:111] offset:35840
    v_accvgpr_read_b32 v41, a73
    v_accvgpr_read_b32 v42, a74
    v_accvgpr_read_b32 v43, a75
    ds_write_b128 v9, a[112:115] offset:36864
    v_accvgpr_read_b32 v44, a76
    v_accvgpr_read_b32 v45, a77
    v_accvgpr_read_b32 v46, a78
    ds_write_b128 v9, a[116:119] offset:37888
    v_accvgpr_read_b32 v47, a79
    v_accvgpr_read_b32 v48, a80
    v_accvgpr_read_b32 v49, a81
    ds_write_b128 v9, a[120:123] offset:38912
    v_accvgpr_read_b32 v50, a82
    v_accvgpr_read_b32 v51, a83
    v_accvgpr_read_b32 v52, a84
    ds_write_b128 v9, a[124:127] offset:39936
    v_accvgpr_read_b32 v53, a85
    v_accvgpr_read_b32 v54, a86
    v_accvgpr_read_b32 v55, a87
    v_accvgpr_read_b32 v56, a88
    v_accvgpr_read_b32 v57, a89
    v_accvgpr_read_b32 v58, a90
    v_accvgpr_read_b32 v59, a91
    v_accvgpr_read_b32 v60, a92
    v_accvgpr_read_b32 v61, a93
    v_accvgpr_read_b32 v62, a94
    v_accvgpr_read_b32 v63, a95
    ds_write_b32 v11, v96 offset:0
    ds_write_b32 v11, v100 offset:256
    ds_write_b32 v11, v104 offset:512
    ds_write_b32 v11, v108 offset:768
    s_branch M_xbar
M_epi:
    s_cmp_eq_u32 s6, 0
    s_cbranch_scc1 M_own0
    ds_write_b128 v8, a[0:3] offset:0
    ds_write_b128 v8, a[4:7] offset:1024
    ds_write_b128 v8, a[8:11] offset:2048
    ds_write_b128 v8, a[12:15] offset:3072
    ds_write_b128 v8, a[16:19] offset:4096
    ds_write_b128 v8, a[20:23] offset:5120
    ds_write_b128 v8, a[24:27] offset:6144
    ds_write_b128 v8, a[28:31] offset:7168
M_own0:
    s_cmp_eq_u32 s6, 1
    s_cbranch_scc1 M_own1
    ds_write_b128 v8, a[32:35] offset:32768
    ds_write_b128 v8, a[36:39] offset:33792
    ds_write_b128 v8, a[40:43] offset:34816
    ds_write_b128 v8, a[44:47] offset:35840
    ds_write_b128 v8, a[48:51] offset:36864
    ds_write_b128 v8, a[52:55] offset:37888
    ds_write_b128 v8, a[56:59] offset:38912
    ds_write_b128 v8, a[60:63] offset:39936
M_own1:
    s_cmp_eq_u32 s6, 2
    s_cbranch_scc1 M_own2
    ds_write_b128 v9, a[64:67] offset:0
    ds_write_b128 v9, a[68:71] offset:1024
    ds_write_b128 v9, a[72:75] offset:2048
    ds_write_b128 v9, a[76:79] offset:3072
    ds_write_b128 v9, a[80:83] offset:4096
    ds_write_b128 v9, a[84:87] offset:5120
    ds_write_b128 v9, a[88:91] offset:6144
    ds_write_b128 v9, a[92:95] offset:7168
M_own2:
    s_cmp_eq_u32 s6, 3
    s_cbranch_scc1 M_own3
    ds_write_b128 v9, a[96:99] offset:32768
    ds_write_b128 v9, a[100:103] offset:33792
    ds_write_b128 v9, a[104:107] offset:34816
    ds_write_b128 v9, a[108:111] offset:35840
    ds_write_b128 v9, a[112:115] offset:36864
    ds_write_b128 v9, a[116:119] offset:37888
    ds_write_b128 v9, a[120:123] offset:38912
    ds_write_b128 v9, a[124:127] offset:39936
M_own3:
    ds_write_b32 v11, v96 offset:0
    ds_write_b32 v11, v100 offset:256
    ds_write_b32 v11, v104 offset:512
    ds_write_b32 v11, v108 offset:768
    s_cmp_lg_u32 s6, 0
    s_cbranch_scc1 M_rd0
    v_accvgpr_read_b32 v32, a0
    v_accvgpr_read_b32 v33, a1
    v_accvgpr_read_b32 v34, a2
    v_accvgpr_read_b32 v35, a3
    v_accvgpr_read_b32 v36, a4
    v_accvgpr_read_b32 v37, a5
    v_accvgpr_read_b32 v38, a6
    v_accvgpr_read_b32 v39, a7
    v_accvgpr_read_b32 v40, a8
    v_accvgpr_read_b32 v41, a9
    v_accvgpr_read_b32 v42, a10
    v_accvgpr_read_b32 v43, a11
    v_accvgpr_read_b32 v44, a12
    v_accvgpr_read_b32 v45, a13
    v_accvgpr_read_b32 v46, a14
    v_accvgpr_read_b32 v47, a15
    v_accvgpr_read_b32 v48, a16
    v_accvgpr_read_b32 v49, a17
    v_accvgpr_read_b32 v50, a18
    v_accvgpr_read_b32 v51, a19
    v_accvgpr_read_b32 v52, a20
    v_accvgpr_read_b32 v53, a21
    v_accvgpr_read_b32 v54, a22
    v_accvgpr_read_b32 v55, a23
    v_accvgpr_read_b32 v56, a24
    v_accvgpr_read_b32 v57, a25
    v_accvgpr_read_b32 v58, a26
    v_accvgpr_read_b32 v59, a27
    v_accvgpr_read_b32 v60, a28
    v_accvgpr_read_b32 v61, a29
    v_accvgpr_read_b32 v62, a30
    v_accvgpr_read_b32 v63, a31
M_rd0:
    s_cmp_lg_u32 s6, 1
    s_cbranch_scc1 M_rd1
    v_accvgpr_read_b32 v32, a32
    v_accvgpr_read_b32 v33, a33
    v_accvgpr_read_b32 v34, a34
    v_accvgpr_read_b32 v35, a35
    v_accvgpr_read_b32 v36, a36
    v_accvgpr_read_b32 v37, a37
    v_accvgpr_read_b32 v38, a38
    v_accvgpr_read_b32 v39, a39
    v_accvgpr_read_b32 v40, a40
    v_accvgpr_read_b32 v41, a41
    v_accvgpr_read_b32 v42, a42
    v_accvgpr_read_b32 v43, a43
    v_accvgpr_read_b32 v44, a44
    v_accvgpr_read_b32 v45, a45
    v_accvgpr_read_b32 v46, a46
    v_accvgpr_read_b32 v47, a47
    v_accvgpr_read_b32 v48, a48
    v_accvgpr_read_b32 v49, a49
    v_accvgpr_read_b32 v50, a50
    v_accvgpr_read_b32 v51, a51
    v_accvgpr_read_b32 v52, a52
    v_accvgpr_read_b32 v53, a53
    v_accvgpr_read_b32 v54, a54
    v_accvgpr_read_b32 v55, a55
    v_accvgpr_read_b32 v56, a56
    v_accvgpr_read_b32 v57, a57
    v_accvgpr_read_b32 v58, a58
    v_accvgpr_read_b32 v59, a59
    v_accvgpr_read_b32 v60, a60
    v_accvgpr_read_b32 v61, a61
    v_accvgpr_read_b32 v62, a62
    v_accvgpr_read_b32 v63, a63
M_rd1:
    s_cmp_lg_u32 s6, 2
    s_cbranch_scc1 M_rd2
    v_accvgpr_read_b32 v32, a64
    v_accvgpr_read_b32 v33, a65
    v_accvgpr_read_b32 v34, a66
    v_accvgpr_read_b32 v35, a67
    v_accvgpr_read_b32 v36, a68
    v_accvgpr_read_b32 v37, a69
    v_accvgpr_read_b32 v38, a70
    v_accvgpr_read_b32 v39, a71
    v_accvgpr_read_b32 v40, a72
    v_accvgpr_read_b32 v41, a73
    v_accvgpr_read_b32 v42, a74
    v_accvgpr_read_b32 v43, a75
    v_accvgpr_read_b32 v44, a76
    v_accvgpr_read_b32 v45, a77
    v_accvgpr_read_b32 v46, a78
    v_accvgpr_read_b32 v47, a79
    v_accvgpr_read_b32 v48, a80
    v_accvgpr_read_b32 v49, a81
    v_accvgpr_read_b32 v50, a82
    v_accvgpr_read_b32 v51, a83
    v_accvgpr_read_b32 v52, a84
    v_accvgpr_read_b32 v53, a85
    v_accvgpr_read_b32 v54, a86
    v_accvgpr_read_b32 v55, a87
    v_accvgpr_read_b32 v56, a88
    v_accvgpr_read_b32 v57, a89
    v_accvgpr_read_b32 v58, a90
    v_accvgpr_read_b32 v59, a91
    v_accvgpr_read_b32 v60, a92
    v_accvgpr_read_b32 v61, a93
    v_accvgpr_read_b32 v62, a94
    v_accvgpr_read_b32 v63, a95
M_rd2:
    s_cmp_lg_u32 s6, 3
    s_cbranch_scc1 M_rd3
    v_accvgpr_read_b32 v32, a96
    v_accvgpr_read_b32 v33, a97
    v_accvgpr_read_b32 v34, a98
    v_accvgpr_read_b32 v35, a99
    v_accvgpr_read_b32 v36, a100
    v_accvgpr_read_b32 v37, a101
    v_accvgpr_read_b32 v38, a102
    v_accvgpr_read_b32 v39, a103
    v_accvgpr_read_b32 v40, a104
    v_accvgpr_read_b32 v41, a105
    v_accvgpr_read_b32 v42, a106
    v_accvgpr_read_b32 v43, a107
    v_accvgpr_read_b32 v44, a108
    v_accvgpr_read_b32 v45, a109
    v_accvgpr_read_b32 v46, a110
    v_accvgpr_read_b32 v47, a111
    v_accvgpr_read_b32 v48, a112
    v_accvgpr_read_b32 v49, a113
    v_accvgpr_read_b32 v50, a114
    v_accvgpr_read_b32 v51, a115
    v_accvgpr_read_b32 v52, a116
    v_accvgpr_read_b32 v53, a117
    v_accvgpr_read_b32 v54, a118
    v_accvgpr_read_b32 v55, a119
    v_accvgpr_read_b32 v56, a120
    v_accvgpr_read_b32 v57, a121
    v_accvgpr_read_b32 v58, a122
    v_accvgpr_read_b32 v59, a123
    v_accvgpr_read_b32 v60, a124
    v_accvgpr_read_b32 v61, a125
    v_accvgpr_read_b32 v62, a126
    v_accvgpr_read_b32 v63, a127
M_rd3:
M_xbar:
    s_waitcnt lgkmcnt(0)
    s_barrier
    ds_read_b32 v16, v10
    ds_read_b32 v17, v10 offset:1024
    ds_read_b32 v18, v10 offset:2048
    ds_read_b32 v19, v10 offset:3072
    ds_read_b128 v[128:131], v13 offset:0
    ds_read_b128 v[136:139], v13 offset:2048
    ds_read_b128 v[144:147], v13 offset:4096
    ds_read_b128 v[152:155], v13 offset:6144
    ds_read_b128 v[160:163], v14 offset:0
    ds_read_b128 v[168:171], v14 offset:2048
    ds_read_b128 v[176:179], v14 offset:4096
    ds_read_b128 v[184:187], v14 offset:6144
    ds_read_b128 v[192:195], v15 offset:0
    ds_read_b128 v[200:203], v15 offset:2048
    ds_read_b128 v[208:211], v15 offset:4096
    s_waitcnt lgkmcnt(11)
    v_add_f32 v16, v16, v17
    v_add_f32 v18, v18, v19
    ds_read_b128 v[216:219], v15 offset:6144
    ds_read_b128 v[132:135], v13 offset:1024
    ds_read_b128 v[140:143], v13 offset:3072
    ds_read_b128 v[148:151], v13 offset:5120
    v_add_f32 v16, v16, v18
    s_nop 0
    v_rcp_f32 v18, v16
    s_waitcnt lgkmcnt(11)
    v_pk_add_f32 v[32:33], v[32:33], v[128:129]
    v_pk_add_f32 v[34:35], v[34:35], v[130:131]
    v_pk_add_f32 v[40:41], v[40:41], v[136:137]
    v_pk_add_f32 v[42:43], v[42:43], v[138:139]
    v_pk_add_f32 v[48:49], v[48:49], v[144:145]
    v_pk_add_f32 v[50:51], v[50:51], v[146:147]
    v_pk_add_f32 v[56:57], v[56:57], v[152:153]
    v_pk_add_f32 v[58:59], v[58:59], v[154:155]
    ds_read_b128 v[156:159], v13 offset:7168
    ds_read_b128 v[164:167], v14 offset:1024
    ds_read_b128 v[172:175], v14 offset:3072
    ds_read_b128 v[180:183], v14 offset:5120
    s_waitcnt lgkmcnt(11)
    v_pk_add_f32 v[32:33], v[32:33], v[160:161]
    v_pk_add_f32 v[34:35], v[34:35], v[162:163]
    v_pk_add_f32 v[40:41], v[40:41], v[168:169]
    v_pk_add_f32 v[42:43], v[42:43], v[170:171]
    v_pk_add_f32 v[48:49], v[48:49], v[176:177]
    v_pk_add_f32 v[50:51], v[50:51], v[178:179]
    v_pk_add_f32 v[56:57], v[56:57], v[184:185]
    v_pk_add_f32 v[58:59], v[58:59], v[186:187]
    ds_read_b128 v[188:191], v14 offset:7168
    ds_read_b128 v[196:199], v15 offset:1024
    ds_read_b128 v[204:207], v15 offset:3072
    ds_read_b128 v[212:215], v15 offset:5120
    ds_read_b128 v[220:223], v15 offset:7168
    s_waitcnt lgkmcnt(12)
    v_pk_add_f32 v[32:33], v[32:33], v[192:193]
    v_pk_add_f32 v[34:35], v[34:35], v[194:195]
    v_pk_add_f32 v[40:41], v[40:41], v[200:201]
    v_pk_add_f32 v[42:43], v[42:43], v[202:203]
    v_pk_add_f32 v[48:49], v[48:49], v[208:209]
    v_pk_add_f32 v[50:51], v[50:51], v[210:211]
    v_pk_add_f32 v[56:57], v[56:57], v[216:217]
    v_pk_add_f32 v[58:59], v[58:59], v[218:219]
    v_pk_mul_f32 v[32:33], v[32:33], v[18:19] op_sel_hi:[1,0]
    v_pk_mul_f32 v[40:41], v[40:41], v[18:19] op_sel_hi:[1,0]
    v_pk_mul_f32 v[48:49], v[48:49], v[18:19] op_sel_hi:[1,0]
    v_pk_mul_f32 v[56:57], v[56:57], v[18:19] op_sel_hi:[1,0]
    v_cvt_pk_bf16_f32 v224, v32, v40
    v_cvt_pk_bf16_f32 v225, v48, v56
    v_cvt_pk_bf16_f32 v226, v33, v41
    v_cvt_pk_bf16_f32 v227, v49, v57
    global_store_dwordx4 v12, v[224:227], s[38:39] offset:0 sc1
    v_pk_mul_f32 v[34:35], v[34:35], v[18:19] op_sel_hi:[1,0]
    v_pk_mul_f32 v[42:43], v[42:43], v[18:19] op_sel_hi:[1,0]
    v_pk_mul_f32 v[50:51], v[50:51], v[18:19] op_sel_hi:[1,0]
    v_pk_mul_f32 v[58:59], v[58:59], v[18:19] op_sel_hi:[1,0]
    v_cvt_pk_bf16_f32 v228, v34, v42
    v_cvt_pk_bf16_f32 v229, v50, v58
    v_cvt_pk_bf16_f32 v230, v35, v43
    v_cvt_pk_bf16_f32 v231, v51, v59
    global_store_dwordx4 v12, v[228:231], s[38:39] offset:64 sc1
    s_waitcnt lgkmcnt(8)
    v_pk_add_f32 v[36:37], v[36:37], v[132:133]
    v_pk_add_f32 v[38:39], v[38:39], v[134:135]
    v_pk_add_f32 v[44:45], v[44:45], v[140:141]
    v_pk_add_f32 v[46:47], v[46:47], v[142:143]
    v_pk_add_f32 v[52:53], v[52:53], v[148:149]
    v_pk_add_f32 v[54:55], v[54:55], v[150:151]
    v_pk_add_f32 v[60:61], v[60:61], v[156:157]
    v_pk_add_f32 v[62:63], v[62:63], v[158:159]
    s_waitcnt lgkmcnt(4)
    v_pk_add_f32 v[36:37], v[36:37], v[164:165]
    v_pk_add_f32 v[38:39], v[38:39], v[166:167]
    v_pk_add_f32 v[44:45], v[44:45], v[172:173]
    v_pk_add_f32 v[46:47], v[46:47], v[174:175]
    v_pk_add_f32 v[52:53], v[52:53], v[180:181]
    v_pk_add_f32 v[54:55], v[54:55], v[182:183]
    v_pk_add_f32 v[60:61], v[60:61], v[188:189]
    v_pk_add_f32 v[62:63], v[62:63], v[190:191]
    s_waitcnt lgkmcnt(0)
    v_pk_add_f32 v[36:37], v[36:37], v[196:197]
    v_pk_add_f32 v[38:39], v[38:39], v[198:199]
    v_pk_add_f32 v[44:45], v[44:45], v[204:205]
    v_pk_add_f32 v[46:47], v[46:47], v[206:207]
    v_pk_add_f32 v[52:53], v[52:53], v[212:213]
    v_pk_add_f32 v[54:55], v[54:55], v[214:215]
    v_pk_add_f32 v[60:61], v[60:61], v[220:221]
    v_pk_add_f32 v[62:63], v[62:63], v[222:223]
    v_pk_mul_f32 v[36:37], v[36:37], v[18:19] op_sel_hi:[1,0]
    v_pk_mul_f32 v[44:45], v[44:45], v[18:19] op_sel_hi:[1,0]
    v_pk_mul_f32 v[52:53], v[52:53], v[18:19] op_sel_hi:[1,0]
    v_pk_mul_f32 v[60:61], v[60:61], v[18:19] op_sel_hi:[1,0]
    v_cvt_pk_bf16_f32 v232, v36, v44
    v_cvt_pk_bf16_f32 v233, v52, v60
    v_cvt_pk_bf16_f32 v234, v37, v45
    v_cvt_pk_bf16_f32 v235, v53, v61
    global_store_dwordx4 v12, v[232:235], s[38:39] offset:128 sc1
    v_pk_mul_f32 v[38:39], v[38:39], v[18:19] op_sel_hi:[1,0]
    v_pk_mul_f32 v[46:47], v[46:47], v[18:19] op_sel_hi:[1,0]
    v_pk_mul_f32 v[54:55], v[54:55], v[18:19] op_sel_hi:[1,0]
    v_pk_mul_f32 v[62:63], v[62:63], v[18:19] op_sel_hi:[1,0]
    v_cvt_pk_bf16_f32 v236, v38, v46
    v_cvt_pk_bf16_f32 v237, v54, v62
    v_cvt_pk_bf16_f32 v238, v39, v47
    v_cvt_pk_bf16_f32 v239, v55, v63
    global_store_dwordx4 v12, v[236:239], s[38:39] offset:192 sc1
    s_cmp_eq_u32 s15, 1
    s_cbranch_scc1 M_done
    v_mov_b32 v20, 0
    v_mov_b32 v21, 0
    v_mov_b32 v22, 0
    v_mov_b32 v23, 0
    v_pk_fma_f32 v[20:21], v[32:33], v[22:23], v[20:21]
    v_pk_fma_f32 v[20:21], v[34:35], v[22:23], v[20:21]
    v_pk_fma_f32 v[20:21], v[36:37], v[22:23], v[20:21]
    v_pk_fma_f32 v[20:21], v[38:39], v[22:23], v[20:21]
    v_pk_fma_f32 v[20:21], v[40:41], v[22:23], v[20:21]
    v_pk_fma_f32 v[20:21], v[42:43], v[22:23], v[20:21]
    v_pk_fma_f32 v[20:21], v[44:45], v[22:23], v[20:21]
    v_pk_fma_f32 v[20:21], v[46:47], v[22:23], v[20:21]
    v_pk_fma_f32 v[20:21], v[48:49], v[22:23], v[20:21]
    v_pk_fma_f32 v[20:21], v[50:51], v[22:23], v[20:21]
    v_pk_fma_f32 v[20:21], v[52:53], v[22:23], v[20:21]
    v_pk_fma_f32 v[20:21], v[54:55], v[22:23], v[20:21]
    v_pk_fma_f32 v[20:21], v[56:57], v[22:23], v[20:21]
    v_pk_fma_f32 v[20:21], v[58:59], v[22:23], v[20:21]
    v_pk_fma_f32 v[20:21], v[60:61], v[22:23], v[20:21]
    v_pk_fma_f32 v[20:21], v[62:63], v[22:23], v[20:21]
    v_add_f32 v20, v20, v21
    v_cmp_u_f32 vcc, v20, v20
    s_mov_b32 s12, 0x30800000
    s_mov_b32 s13, 0x53800000
    v_cmp_nge_f32 s[10:11], v16, s12
    v_cmp_nle_f32 s[16:17], v16, s13
    s_nop 1
    s_or_b64 vcc, vcc, s[10:11]
    s_or_b64 vcc, vcc, s[16:17]
    s_cmp_lg_u64 vcc, 0
    s_cselect_b32 s12, 1, 0
    v_mov_b32 v20, s12
    s_lshl_b32 s13, s6, 2
    s_add_u32 s13, s13, 139264
    v_mov_b32 v21, s13
    ds_write_b32 v21, v20
    s_waitcnt lgkmcnt(0)
    s_barrier
    v_mov_b32 v21, 139264
    ds_read_b128 v[24:27], v21
    s_waitcnt lgkmcnt(0)
    v_or3_b32 v24, v24, v25, v26
    v_or_b32 v24, v24, v27
    s_nop 0
    v_readfirstlane_b32 s12, v24
    s_nop 0
    s_cmp_lg_u32 s12, 0
    s_cbranch_scc1 M_slow
M_done:
    s_endpgm
M_slow:
    s_waitcnt vmcnt(0)
    s_mov_b32 s15, 1
    v_accvgpr_write_b32 a0, 0
    v_accvgpr_write_b32 a1, 0
    v_accvgpr_write_b32 a2, 0
    v_accvgpr_write_b32 a3, 0
    v_accvgpr_write_b32 a4, 0
    v_accvgpr_write_b32 a5, 0
    v_accvgpr_write_b32 a6, 0
    v_accvgpr_write_b32 a7, 0
    v_accvgpr_write_b32 a8, 0
    v_accvgpr_write_b32 a9, 0
    v_accvgpr_write_b32 a10, 0
    v_accvgpr_write_b32 a11, 0
    v_accvgpr_write_b32 a12, 0
    v_accvgpr_write_b32 a13, 0
    v_accvgpr_write_b32 a14, 0
    v_accvgpr_write_b32 a15, 0
    v_accvgpr_write_b32 a16, 0
    v_accvgpr_write_b32 a17, 0
    v_accvgpr_write_b32 a18, 0
    v_accvgpr_write_b32 a19, 0
    v_accvgpr_write_b32 a20, 0
    v_accvgpr_write_b32 a21, 0
    v_accvgpr_write_b32 a22, 0
    v_accvgpr_write_b32 a23, 0
    v_accvgpr_write_b32 a24, 0
    v_accvgpr_write_b32 a25, 0
    v_accvgpr_write_b32 a26, 0
    v_accvgpr_write_b32 a27, 0
    v_accvgpr_write_b32 a28, 0
    v_accvgpr_write_b32 a29, 0
    v_accvgpr_write_b32 a30, 0
    v_accvgpr_write_b32 a31, 0
    v_accvgpr_write_b32 a32, 0
    v_accvgpr_write_b32 a33, 0
    v_accvgpr_write_b32 a34, 0
    v_accvgpr_write_b32 a35, 0
    v_accvgpr_write_b32 a36, 0
    v_accvgpr_write_b32 a37, 0
    v_accvgpr_write_b32 a38, 0
    v_accvgpr_write_b32 a39, 0
    v_accvgpr_write_b32 a40, 0
    v_accvgpr_write_b32 a41, 0
    v_accvgpr_write_b32 a42, 0
    v_accvgpr_write_b32 a43, 0
    v_accvgpr_write_b32 a44, 0
    v_accvgpr_write_b32 a45, 0
    v_accvgpr_write_b32 a46, 0
    v_accvgpr_write_b32 a47, 0
    v_accvgpr_write_b32 a48, 0
    v_accvgpr_write_b32 a49, 0
    v_accvgpr_write_b32 a50, 0
    v_accvgpr_write_b32 a51, 0
    v_accvgpr_write_b32 a52, 0
    v_accvgpr_write_b32 a53, 0
    v_accvgpr_write_b32 a54, 0
    v_accvgpr_write_b32 a55, 0
    v_accvgpr_write_b32 a56, 0
    v_accvgpr_write_b32 a57, 0
    v_accvgpr_write_b32 a58, 0
    v_accvgpr_write_b32 a59, 0
    v_accvgpr_write_b32 a60, 0
    v_accvgpr_write_b32 a61, 0
    v_accvgpr_write_b32 a62, 0
    v_accvgpr_write_b32 a63, 0
    v_accvgpr_write_b32 a64, 0
    v_accvgpr_write_b32 a65, 0
    v_accvgpr_write_b32 a66, 0
    v_accvgpr_write_b32 a67, 0
    v_accvgpr_write_b32 a68, 0
    v_accvgpr_write_b32 a69, 0
    v_accvgpr_write_b32 a70, 0
    v_accvgpr_write_b32 a71, 0
    v_accvgpr_write_b32 a72, 0
    v_accvgpr_write_b32 a73, 0
    v_accvgpr_write_b32 a74, 0
    v_accvgpr_write_b32 a75, 0
    v_accvgpr_write_b32 a76, 0
    v_accvgpr_write_b32 a77, 0
    v_accvgpr_write_b32 a78, 0
    v_accvgpr_write_b32 a79, 0
    v_accvgpr_write_b32 a80, 0
    v_accvgpr_write_b32 a81, 0
    v_accvgpr_write_b32 a82, 0
    v_accvgpr_write_b32 a83, 0
    v_accvgpr_write_b32 a84, 0
    v_accvgpr_write_b32 a85, 0
    v_accvgpr_write_b32 a86, 0
    v_accvgpr_write_b32 a87, 0
    v_accvgpr_write_b32 a88, 0
    v_accvgpr_write_b32 a89, 0
    v_accvgpr_write_b32 a90, 0
    v_accvgpr_write_b32 a91, 0
    v_accvgpr_write_b32 a92, 0
    v_accvgpr_write_b32 a93, 0
    v_accvgpr_write_b32 a94, 0
    v_accvgpr_write_b32 a95, 0
    v_accvgpr_write_b32 a96, 0
    v_accvgpr_write_b32 a97, 0
    v_accvgpr_write_b32 a98, 0
    v_accvgpr_write_b32 a99, 0
    v_accvgpr_write_b32 a100, 0
    v_accvgpr_write_b32 a101, 0
    v_accvgpr_write_b32 a102, 0
    v_accvgpr_write_b32 a103, 0
    v_accvgpr_write_b32 a104, 0
    v_accvgpr_write_b32 a105, 0
    v_accvgpr_write_b32 a106, 0
    v_accvgpr_write_b32 a107, 0
    v_accvgpr_write_b32 a108, 0
    v_accvgpr_write_b32 a109, 0
    v_accvgpr_write_b32 a110, 0
    v_accvgpr_write_b32 a111, 0
    v_accvgpr_write_b32 a112, 0
    v_accvgpr_write_b32 a113, 0
    v_accvgpr_write_b32 a114, 0
    v_accvgpr_write_b32 a115, 0
    v_accvgpr_write_b32 a116, 0
    v_accvgpr_write_b32 a117, 0
    v_accvgpr_write_b32 a118, 0
    v_accvgpr_write_b32 a119, 0
    v_accvgpr_write_b32 a120, 0
    v_accvgpr_write_b32 a121, 0
    v_accvgpr_write_b32 a122, 0
    v_accvgpr_write_b32 a123, 0
    v_accvgpr_write_b32 a124, 0
    v_accvgpr_write_b32 a125, 0
    v_accvgpr_write_b32 a126, 0
    v_accvgpr_write_b32 a127, 0
    v_mov_b32 v96, 0
    v_mov_b32 v97, 0
    v_mov_b32 v98, 0
    v_mov_b32 v99, 0
    v_mov_b32 v100, 0
    v_mov_b32 v101, 0
    v_mov_b32 v102, 0
    v_mov_b32 v103, 0
    v_mov_b32 v104, 0
    v_mov_b32 v105, 0
    v_mov_b32 v106, 0
    v_mov_b32 v107, 0
    v_mov_b32 v108, 0
    v_mov_b32 v109, 0
    v_mov_b32 v110, 0
    v_mov_b32 v111, 0
    v_mov_b32 v88, 0x3f803f80
    v_mov_b32 v89, 0x3f803f80
    v_mov_b32 v90, 0x3f803f80
    v_mov_b32 v91, 0x3f803f80
    v_mov_b32 v80, 0xff7fffff
    v_mov_b32 v81, 0xff7fffff
    v_mov_b32 v82, 0xff7fffff
    v_mov_b32 v83, 0xff7fffff
    s_mov_b32 s52, 0
M_slow_loop:
    buffer_load_dwordx4 a[192:195], v4, s[48:51], s52 offen offset:0 sc1
    buffer_load_dwordx4 a[196:199], v4, s[48:51], s52 offen offset:1024 sc1
    buffer_load_dwordx4 a[200:203], v4, s[48:51], s52 offen offset:2048 sc1
    buffer_load_dwordx4 a[204:207], v4, s[48:51], s52 offen offset:3072 sc1
    buffer_load_dwordx4 a[208:211], v5, s[48:51], s52 offen offset:0 sc1
    buffer_load_dwordx4 a[212:215], v5, s[48:51], s52 offen offset:1024 sc1
    buffer_load_dwordx4 a[216:219], v5, s[48:51], s52 offen offset:2048 sc1
    buffer_load_dwordx4 a[220:223], v5, s[48:51], s52 offen offset:3072 sc1
    buffer_load_dwordx4 v[128:131], v6, s[48:51], s52 offen offset:0 sc1
    buffer_load_dwordx4 v[132:135], v6, s[48:51], s52 offen offset:1024 sc1
    buffer_load_dwordx4 v[136:139], v6, s[48:51], s52 offen offset:2048 sc1
    buffer_load_dwordx4 v[140:143], v6, s[48:51], s52 offen offset:3072 sc1
    buffer_load_dwordx4 v[144:147], v7, s[48:51], s52 offen offset:0 sc1
    buffer_load_dwordx4 v[148:151], v7, s[48:51], s52 offen offset:1024 sc1
    buffer_load_dwordx4 v[152:155], v7, s[48:51], s52 offen offset:2048 sc1
    buffer_load_dwordx4 v[156:159], v7, s[48:51], s52 offen offset:3072 sc1
    s_waitcnt vmcnt(0)
    v_mfma_f32_16x16x32_bf16 v[32:35], a[192:195], a[128:131], 0
    v_mfma_f32_16x16x32_bf16 v[40:43], a[192:195], a[144:147], 0
    v_mfma_f32_16x16x32_bf16 v[36:39], a[208:211], a[128:131], 0
    v_mfma_f32_16x16x32_bf16 v[44:47], a[208:211], a[144:147], 0
    v_mfma_f32_16x16x32_bf16 v[32:35], a[196:199], a[132:135], v[32:35]
    v_mfma_f32_16x16x32_bf16 v[40:43], a[196:199], a[148:151], v[40:43]
    v_mfma_f32_16x16x32_bf16 v[36:39], a[212:215], a[132:135], v[36:39]
    v_mfma_f32_16x16x32_bf16 v[44:47], a[212:215], a[148:151], v[44:47]
    v_mfma_f32_16x16x32_bf16 v[32:35], a[200:203], a[136:139], v[32:35]
    v_mfma_f32_16x16x32_bf16 v[40:43], a[200:203], a[152:155], v[40:43]
    v_mfma_f32_16x16x32_bf16 v[36:39], a[216:219], a[136:139], v[36:39]
    v_mfma_f32_16x16x32_bf16 v[44:47], a[216:219], a[152:155], v[44:47]
    v_mfma_f32_16x16x32_bf16 v[32:35], a[204:207], a[140:143], v[32:35]
    v_mfma_f32_16x16x32_bf16 v[40:43], a[204:207], a[156:159], v[40:43]
    v_mfma_f32_16x16x32_bf16 v[36:39], a[220:223], a[140:143], v[36:39]
    v_mfma_f32_16x16x32_bf16 v[44:47], a[220:223], a[156:159], v[44:47]
    v_mfma_f32_16x16x32_bf16 v[48:51], a[192:195], a[160:163], 0
    v_mfma_f32_16x16x32_bf16 v[56:59], a[192:195], a[176:179], 0
    v_mfma_f32_16x16x32_bf16 v[52:55], a[208:211], a[160:163], 0
    v_mfma_f32_16x16x32_bf16 v[60:63], a[208:211], a[176:179], 0
    v_mfma_f32_16x16x32_bf16 v[48:51], a[196:199], a[164:167], v[48:51]
    v_mfma_f32_16x16x32_bf16 v[56:59], a[196:199], a[180:183], v[56:59]
    v_mfma_f32_16x16x32_bf16 v[52:55], a[212:215], a[164:167], v[52:55]
    v_mfma_f32_16x16x32_bf16 v[60:63], a[212:215], a[180:183], v[60:63]
    v_mfma_f32_16x16x32_bf16 v[48:51], a[200:203], a[168:171], v[48:51]
    v_mfma_f32_16x16x32_bf16 v[56:59], a[200:203], a[184:187], v[56:59]
    v_mfma_f32_16x16x32_bf16 v[52:55], a[216:219], a[168:171], v[52:55]
    v_mfma_f32_16x16x32_bf16 v[60:63], a[216:219], a[184:187], v[60:63]
    v_mfma_f32_16x16x32_bf16 v[48:51], a[204:207], a[172:175], v[48:51]
    v_mfma_f32_16x16x32_bf16 v[56:59], a[204:207], a[188:191], v[56:59]
    v_mfma_f32_16x16x32_bf16 v[52:55], a[220:223], a[172:175], v[52:55]
    v_mfma_f32_16x16x32_bf16 v[60:63], a[220:223], a[188:191], v[60:63]
    s_nop 7
    s_nop 1
    v_max3_f32 v16, v32, v33, v34
    v_max3_f32 v16, v16, v35, v36
    v_max3_f32 v16, v16, v37, v38
    v_max3_f32 v16, v16, v39, v80
    v_mov_b32 v17, v16
    s_nop 1
    v_permlane16_swap_b32 v16, v17
    v_max_f32 v16, v16, v17
    v_mov_b32 v17, v16
    s_nop 1
    v_permlane32_swap_b32 v16, v17
    v_max_f32 v16, v16, v17
    v_sub_f32 v18, v80, v16
    v_exp_f32 v18, v18
    v_mov_b32 v80, v16
    v_sub_f32 v32, v32, v16
    v_sub_f32 v33, v33, v16
    v_sub_f32 v34, v34, v16
    v_sub_f32 v35, v35, v16
    v_sub_f32 v36, v36, v16
    v_sub_f32 v37, v37, v16
    v_sub_f32 v38, v38, v16
    v_sub_f32 v39, v39, v16
    v_exp_f32 v32, v32
    v_exp_f32 v33, v33
    v_exp_f32 v34, v34
    v_exp_f32 v35, v35
    v_exp_f32 v36, v36
    v_exp_f32 v37, v37
    v_exp_f32 v38, v38
    v_exp_f32 v39, v39
    s_nop 0
    v_cvt_pk_bf16_f32 v64, v32, v33
    v_cvt_pk_bf16_f32 v65, v34, v35
    v_cvt_pk_bf16_f32 v66, v36, v37
    v_cvt_pk_bf16_f32 v67, v38, v39
    v_mul_f32 v96, v96, v18
    v_mul_f32 v97, v97, v18
    v_mul_f32 v98, v98, v18
    v_mul_f32 v99, v99, v18
    v_accvgpr_read_b32 v19, a0
    v_mul_f32 v19, v19, v18
    v_accvgpr_write_b32 a0, v19
    v_accvgpr_read_b32 v19, a1
    v_mul_f32 v19, v19, v18
    v_accvgpr_write_b32 a1, v19
    v_accvgpr_read_b32 v19, a2
    v_mul_f32 v19, v19, v18
    v_accvgpr_write_b32 a2, v19
    v_accvgpr_read_b32 v19, a3
    v_mul_f32 v19, v19, v18
    v_accvgpr_write_b32 a3, v19
    v_accvgpr_read_b32 v19, a4
    v_mul_f32 v19, v19, v18
    v_accvgpr_write_b32 a4, v19
    v_accvgpr_read_b32 v19, a5
    v_mul_f32 v19, v19, v18
    v_accvgpr_write_b32 a5, v19
    v_accvgpr_read_b32 v19, a6
    v_mul_f32 v19, v19, v18
    v_accvgpr_write_b32 a6, v19
    v_accvgpr_read_b32 v19, a7
    v_mul_f32 v19, v19, v18
    v_accvgpr_write_b32 a7, v19
    v_accvgpr_read_b32 v19, a8
    v_mul_f32 v19, v19, v18
    v_accvgpr_write_b32 a8, v19
    v_accvgpr_read_b32 v19, a9
    v_mul_f32 v19, v19, v18
    v_accvgpr_write_b32 a9, v19
    v_accvgpr_read_b32 v19, a10
    v_mul_f32 v19, v19, v18
    v_accvgpr_write_b32 a10, v19
    v_accvgpr_read_b32 v19, a11
    v_mul_f32 v19, v19, v18
    v_accvgpr_write_b32 a11, v19
    v_accvgpr_read_b32 v19, a12
    v_mul_f32 v19, v19, v18
    v_accvgpr_write_b32 a12, v19
    v_accvgpr_read_b32 v19, a13
    v_mul_f32 v19, v19, v18
    v_accvgpr_write_b32 a13, v19
    v_accvgpr_read_b32 v19, a14
    v_mul_f32 v19, v19, v18
    v_accvgpr_write_b32 a14, v19
    v_accvgpr_read_b32 v19, a15
    v_mul_f32 v19, v19, v18
    v_accvgpr_write_b32 a15, v19
    v_accvgpr_read_b32 v19, a16
    v_mul_f32 v19, v19, v18
    v_accvgpr_write_b32 a16, v19
    v_accvgpr_read_b32 v19, a17
    v_mul_f32 v19, v19, v18
    v_accvgpr_write_b32 a17, v19
    v_accvgpr_read_b32 v19, a18
    v_mul_f32 v19, v19, v18
    v_accvgpr_write_b32 a18, v19
    v_accvgpr_read_b32 v19, a19
    v_mul_f32 v19, v19, v18
    v_accvgpr_write_b32 a19, v19
    v_accvgpr_read_b32 v19, a20
    v_mul_f32 v19, v19, v18
    v_accvgpr_write_b32 a20, v19
    v_accvgpr_read_b32 v19, a21
    v_mul_f32 v19, v19, v18
    v_accvgpr_write_b32 a21, v19
    v_accvgpr_read_b32 v19, a22
    v_mul_f32 v19, v19, v18
    v_accvgpr_write_b32 a22, v19
    v_accvgpr_read_b32 v19, a23
    v_mul_f32 v19, v19, v18
    v_accvgpr_write_b32 a23, v19
    v_accvgpr_read_b32 v19, a24
    v_mul_f32 v19, v19, v18
    v_accvgpr_write_b32 a24, v19
    v_accvgpr_read_b32 v19, a25
    v_mul_f32 v19, v19, v18
    v_accvgpr_write_b32 a25, v19
    v_accvgpr_read_b32 v19, a26
    v_mul_f32 v19, v19, v18
    v_accvgpr_write_b32 a26, v19
    v_accvgpr_read_b32 v19, a27
    v_mul_f32 v19, v19, v18
    v_accvgpr_write_b32 a27, v19
    v_accvgpr_read_b32 v19, a28
    v_mul_f32 v19, v19, v18
    v_accvgpr_write_b32 a28, v19
    v_accvgpr_read_b32 v19, a29
    v_mul_f32 v19, v19, v18
    v_accvgpr_write_b32 a29, v19
    v_accvgpr_read_b32 v19, a30
    v_mul_f32 v19, v19, v18
    v_accvgpr_write_b32 a30, v19
    v_accvgpr_read_b32 v19, a31
    v_mul_f32 v19, v19, v18
    v_accvgpr_write_b32 a31, v19
    v_max3_f32 v16, v40, v41, v42
    v_max3_f32 v16, v16, v43, v44
    v_max3_f32 v16, v16, v45, v46
    v_max3_f32 v16, v16, v47, v81
    v_mov_b32 v17, v16
    s_nop 1
    v_permlane16_swap_b32 v16, v17
    v_max_f32 v16, v16, v17
    v_mov_b32 v17, v16
    s_nop 1
    v_permlane32_swap_b32 v16, v17
    v_max_f32 v16, v16, v17
    v_sub_f32 v18, v81, v16
    v_exp_f32 v18, v18
    v_mov_b32 v81, v16
    v_sub_f32 v40, v40, v16
    v_sub_f32 v41, v41, v16
    v_sub_f32 v42, v42, v16
    v_sub_f32 v43, v43, v16
    v_sub_f32 v44, v44, v16
    v_sub_f32 v45, v45, v16
    v_sub_f32 v46, v46, v16
    v_sub_f32 v47, v47, v16
    v_exp_f32 v40, v40
    v_exp_f32 v41, v41
    v_exp_f32 v42, v42
    v_exp_f32 v43, v43
    v_exp_f32 v44, v44
    v_exp_f32 v45, v45
    v_exp_f32 v46, v46
    v_exp_f32 v47, v47
    s_nop 0
    v_cvt_pk_bf16_f32 v68, v40, v41
    v_cvt_pk_bf16_f32 v69, v42, v43
    v_cvt_pk_bf16_f32 v70, v44, v45
    v_cvt_pk_bf16_f32 v71, v46, v47
    v_mul_f32 v100, v100, v18
    v_mul_f32 v101, v101, v18
    v_mul_f32 v102, v102, v18
    v_mul_f32 v103, v103, v18
    v_accvgpr_read_b32 v19, a32
    v_mul_f32 v19, v19, v18
    v_accvgpr_write_b32 a32, v19
    v_accvgpr_read_b32 v19, a33
    v_mul_f32 v19, v19, v18
    v_accvgpr_write_b32 a33, v19
    v_accvgpr_read_b32 v19, a34
    v_mul_f32 v19, v19, v18
    v_accvgpr_write_b32 a34, v19
    v_accvgpr_read_b32 v19, a35
    v_mul_f32 v19, v19, v18
    v_accvgpr_write_b32 a35, v19
    v_accvgpr_read_b32 v19, a36
    v_mul_f32 v19, v19, v18
    v_accvgpr_write_b32 a36, v19
    v_accvgpr_read_b32 v19, a37
    v_mul_f32 v19, v19, v18
    v_accvgpr_write_b32 a37, v19
    v_accvgpr_read_b32 v19, a38
    v_mul_f32 v19, v19, v18
    v_accvgpr_write_b32 a38, v19
    v_accvgpr_read_b32 v19, a39
    v_mul_f32 v19, v19, v18
    v_accvgpr_write_b32 a39, v19
    v_accvgpr_read_b32 v19, a40
    v_mul_f32 v19, v19, v18
    v_accvgpr_write_b32 a40, v19
    v_accvgpr_read_b32 v19, a41
    v_mul_f32 v19, v19, v18
    v_accvgpr_write_b32 a41, v19
    v_accvgpr_read_b32 v19, a42
    v_mul_f32 v19, v19, v18
    v_accvgpr_write_b32 a42, v19
    v_accvgpr_read_b32 v19, a43
    v_mul_f32 v19, v19, v18
    v_accvgpr_write_b32 a43, v19
    v_accvgpr_read_b32 v19, a44
    v_mul_f32 v19, v19, v18
    v_accvgpr_write_b32 a44, v19
    v_accvgpr_read_b32 v19, a45
    v_mul_f32 v19, v19, v18
    v_accvgpr_write_b32 a45, v19
    v_accvgpr_read_b32 v19, a46
    v_mul_f32 v19, v19, v18
    v_accvgpr_write_b32 a46, v19
    v_accvgpr_read_b32 v19, a47
    v_mul_f32 v19, v19, v18
    v_accvgpr_write_b32 a47, v19
    v_accvgpr_read_b32 v19, a48
    v_mul_f32 v19, v19, v18
    v_accvgpr_write_b32 a48, v19
    v_accvgpr_read_b32 v19, a49
    v_mul_f32 v19, v19, v18
    v_accvgpr_write_b32 a49, v19
    v_accvgpr_read_b32 v19, a50
    v_mul_f32 v19, v19, v18
    v_accvgpr_write_b32 a50, v19
    v_accvgpr_read_b32 v19, a51
    v_mul_f32 v19, v19, v18
    v_accvgpr_write_b32 a51, v19
    v_accvgpr_read_b32 v19, a52
    v_mul_f32 v19, v19, v18
    v_accvgpr_write_b32 a52, v19
    v_accvgpr_read_b32 v19, a53
    v_mul_f32 v19, v19, v18
    v_accvgpr_write_b32 a53, v19
    v_accvgpr_read_b32 v19, a54
    v_mul_f32 v19, v19, v18
    v_accvgpr_write_b32 a54, v19
    v_accvgpr_read_b32 v19, a55
    v_mul_f32 v19, v19, v18
    v_accvgpr_write_b32 a55, v19
    v_accvgpr_read_b32 v19, a56
    v_mul_f32 v19, v19, v18
    v_accvgpr_write_b32 a56, v19
    v_accvgpr_read_b32 v19, a57
    v_mul_f32 v19, v19, v18
    v_accvgpr_write_b32 a57, v19
    v_accvgpr_read_b32 v19, a58
    v_mul_f32 v19, v19, v18
    v_accvgpr_write_b32 a58, v19
    v_accvgpr_read_b32 v19, a59
    v_mul_f32 v19, v19, v18
    v_accvgpr_write_b32 a59, v19
    v_accvgpr_read_b32 v19, a60
    v_mul_f32 v19, v19, v18
    v_accvgpr_write_b32 a60, v19
    v_accvgpr_read_b32 v19, a61
    v_mul_f32 v19, v19, v18
    v_accvgpr_write_b32 a61, v19
    v_accvgpr_read_b32 v19, a62
    v_mul_f32 v19, v19, v18
    v_accvgpr_write_b32 a62, v19
    v_accvgpr_read_b32 v19, a63
    v_mul_f32 v19, v19, v18
    v_accvgpr_write_b32 a63, v19
    v_max3_f32 v16, v48, v49, v50
    v_max3_f32 v16, v16, v51, v52
    v_max3_f32 v16, v16, v53, v54
    v_max3_f32 v16, v16, v55, v82
    v_mov_b32 v17, v16
    s_nop 1
    v_permlane16_swap_b32 v16, v17
    v_max_f32 v16, v16, v17
    v_mov_b32 v17, v16
    s_nop 1
    v_permlane32_swap_b32 v16, v17
    v_max_f32 v16, v16, v17
    v_sub_f32 v18, v82, v16
    v_exp_f32 v18, v18
    v_mov_b32 v82, v16
    v_sub_f32 v48, v48, v16
    v_sub_f32 v49, v49, v16
    v_sub_f32 v50, v50, v16
    v_sub_f32 v51, v51, v16
    v_sub_f32 v52, v52, v16
    v_sub_f32 v53, v53, v16
    v_sub_f32 v54, v54, v16
    v_sub_f32 v55, v55, v16
    v_exp_f32 v48, v48
    v_exp_f32 v49, v49
    v_exp_f32 v50, v50
    v_exp_f32 v51, v51
    v_exp_f32 v52, v52
    v_exp_f32 v53, v53
    v_exp_f32 v54, v54
    v_exp_f32 v55, v55
    s_nop 0
    v_cvt_pk_bf16_f32 v72, v48, v49
    v_cvt_pk_bf16_f32 v73, v50, v51
    v_cvt_pk_bf16_f32 v74, v52, v53
    v_cvt_pk_bf16_f32 v75, v54, v55
    v_mul_f32 v104, v104, v18
    v_mul_f32 v105, v105, v18
    v_mul_f32 v106, v106, v18
    v_mul_f32 v107, v107, v18
    v_accvgpr_read_b32 v19, a64
    v_mul_f32 v19, v19, v18
    v_accvgpr_write_b32 a64, v19
    v_accvgpr_read_b32 v19, a65
    v_mul_f32 v19, v19, v18
    v_accvgpr_write_b32 a65, v19
    v_accvgpr_read_b32 v19, a66
    v_mul_f32 v19, v19, v18
    v_accvgpr_write_b32 a66, v19
    v_accvgpr_read_b32 v19, a67
    v_mul_f32 v19, v19, v18
    v_accvgpr_write_b32 a67, v19
    v_accvgpr_read_b32 v19, a68
    v_mul_f32 v19, v19, v18
    v_accvgpr_write_b32 a68, v19
    v_accvgpr_read_b32 v19, a69
    v_mul_f32 v19, v19, v18
    v_accvgpr_write_b32 a69, v19
    v_accvgpr_read_b32 v19, a70
    v_mul_f32 v19, v19, v18
    v_accvgpr_write_b32 a70, v19
    v_accvgpr_read_b32 v19, a71
    v_mul_f32 v19, v19, v18
    v_accvgpr_write_b32 a71, v19
    v_accvgpr_read_b32 v19, a72
    v_mul_f32 v19, v19, v18
    v_accvgpr_write_b32 a72, v19
    v_accvgpr_read_b32 v19, a73
    v_mul_f32 v19, v19, v18
    v_accvgpr_write_b32 a73, v19
    v_accvgpr_read_b32 v19, a74
    v_mul_f32 v19, v19, v18
    v_accvgpr_write_b32 a74, v19
    v_accvgpr_read_b32 v19, a75
    v_mul_f32 v19, v19, v18
    v_accvgpr_write_b32 a75, v19
    v_accvgpr_read_b32 v19, a76
    v_mul_f32 v19, v19, v18
    v_accvgpr_write_b32 a76, v19
    v_accvgpr_read_b32 v19, a77
    v_mul_f32 v19, v19, v18
    v_accvgpr_write_b32 a77, v19
    v_accvgpr_read_b32 v19, a78
    v_mul_f32 v19, v19, v18
    v_accvgpr_write_b32 a78, v19
    v_accvgpr_read_b32 v19, a79
    v_mul_f32 v19, v19, v18
    v_accvgpr_write_b32 a79, v19
    v_accvgpr_read_b32 v19, a80
    v_mul_f32 v19, v19, v18
    v_accvgpr_write_b32 a80, v19
    v_accvgpr_read_b32 v19, a81
    v_mul_f32 v19, v19, v18
    v_accvgpr_write_b32 a81, v19
    v_accvgpr_read_b32 v19, a82
    v_mul_f32 v19, v19, v18
    v_accvgpr_write_b32 a82, v19
    v_accvgpr_read_b32 v19, a83
    v_mul_f32 v19, v19, v18
    v_accvgpr_write_b32 a83, v19
    v_accvgpr_read_b32 v19, a84
    v_mul_f32 v19, v19, v18
    v_accvgpr_write_b32 a84, v19
    v_accvgpr_read_b32 v19, a85
    v_mul_f32 v19, v19, v18
    v_accvgpr_write_b32 a85, v19
    v_accvgpr_read_b32 v19, a86
    v_mul_f32 v19, v19, v18
    v_accvgpr_write_b32 a86, v19
    v_accvgpr_read_b32 v19, a87
    v_mul_f32 v19, v19, v18
    v_accvgpr_write_b32 a87, v19
    v_accvgpr_read_b32 v19, a88
    v_mul_f32 v19, v19, v18
    v_accvgpr_write_b32 a88, v19
    v_accvgpr_read_b32 v19, a89
    v_mul_f32 v19, v19, v18
    v_accvgpr_write_b32 a89, v19
    v_accvgpr_read_b32 v19, a90
    v_mul_f32 v19, v19, v18
    v_accvgpr_write_b32 a90, v19
    v_accvgpr_read_b32 v19, a91
    v_mul_f32 v19, v19, v18
    v_accvgpr_write_b32 a91, v19
    v_accvgpr_read_b32 v19, a92
    v_mul_f32 v19, v19, v18
    v_accvgpr_write_b32 a92, v19
    v_accvgpr_read_b32 v19, a93
    v_mul_f32 v19, v19, v18
    v_accvgpr_write_b32 a93, v19
    v_accvgpr_read_b32 v19, a94
    v_mul_f32 v19, v19, v18
    v_accvgpr_write_b32 a94, v19
    v_accvgpr_read_b32 v19, a95
    v_mul_f32 v19, v19, v18
    v_accvgpr_write_b32 a95, v19
    v_max3_f32 v16, v56, v57, v58
    v_max3_f32 v16, v16, v59, v60
    v_max3_f32 v16, v16, v61, v62
    v_max3_f32 v16, v16, v63, v83
    v_mov_b32 v17, v16
    s_nop 1
    v_permlane16_swap_b32 v16, v17
    v_max_f32 v16, v16, v17
    v_mov_b32 v17, v16
    s_nop 1
    v_permlane32_swap_b32 v16, v17
    v_max_f32 v16, v16, v17
    v_sub_f32 v18, v83, v16
    v_exp_f32 v18, v18
    v_mov_b32 v83, v16
    v_sub_f32 v56, v56, v16
    v_sub_f32 v57, v57, v16
    v_sub_f32 v58, v58, v16
    v_sub_f32 v59, v59, v16
    v_sub_f32 v60, v60, v16
    v_sub_f32 v61, v61, v16
    v_sub_f32 v62, v62, v16
    v_sub_f32 v63, v63, v16
    v_exp_f32 v56, v56
    v_exp_f32 v57, v57
    v_exp_f32 v58, v58
    v_exp_f32 v59, v59
    v_exp_f32 v60, v60
    v_exp_f32 v61, v61
    v_exp_f32 v62, v62
    v_exp_f32 v63, v63
    s_nop 0
    v_cvt_pk_bf16_f32 v76, v56, v57
    v_cvt_pk_bf16_f32 v77, v58, v59
    v_cvt_pk_bf16_f32 v78, v60, v61
    v_cvt_pk_bf16_f32 v79, v62, v63
    v_mul_f32 v108, v108, v18
    v_mul_f32 v109, v109, v18
    v_mul_f32 v110, v110, v18
    v_mul_f32 v111, v111, v18
    v_accvgpr_read_b32 v19, a96
    v_mul_f32 v19, v19, v18
    v_accvgpr_write_b32 a96, v19
    v_accvgpr_read_b32 v19, a97
    v_mul_f32 v19, v19, v18
    v_accvgpr_write_b32 a97, v19
    v_accvgpr_read_b32 v19, a98
    v_mul_f32 v19, v19, v18
    v_accvgpr_write_b32 a98, v19
    v_accvgpr_read_b32 v19, a99
    v_mul_f32 v19, v19, v18
    v_accvgpr_write_b32 a99, v19
    v_accvgpr_read_b32 v19, a100
    v_mul_f32 v19, v19, v18
    v_accvgpr_write_b32 a100, v19
    v_accvgpr_read_b32 v19, a101
    v_mul_f32 v19, v19, v18
    v_accvgpr_write_b32 a101, v19
    v_accvgpr_read_b32 v19, a102
    v_mul_f32 v19, v19, v18
    v_accvgpr_write_b32 a102, v19
    v_accvgpr_read_b32 v19, a103
    v_mul_f32 v19, v19, v18
    v_accvgpr_write_b32 a103, v19
    v_accvgpr_read_b32 v19, a104
    v_mul_f32 v19, v19, v18
    v_accvgpr_write_b32 a104, v19
    v_accvgpr_read_b32 v19, a105
    v_mul_f32 v19, v19, v18
    v_accvgpr_write_b32 a105, v19
    v_accvgpr_read_b32 v19, a106
    v_mul_f32 v19, v19, v18
    v_accvgpr_write_b32 a106, v19
    v_accvgpr_read_b32 v19, a107
    v_mul_f32 v19, v19, v18
    v_accvgpr_write_b32 a107, v19
    v_accvgpr_read_b32 v19, a108
    v_mul_f32 v19, v19, v18
    v_accvgpr_write_b32 a108, v19
    v_accvgpr_read_b32 v19, a109
    v_mul_f32 v19, v19, v18
    v_accvgpr_write_b32 a109, v19
    v_accvgpr_read_b32 v19, a110
    v_mul_f32 v19, v19, v18
    v_accvgpr_write_b32 a110, v19
    v_accvgpr_read_b32 v19, a111
    v_mul_f32 v19, v19, v18
    v_accvgpr_write_b32 a111, v19
    v_accvgpr_read_b32 v19, a112
    v_mul_f32 v19, v19, v18
    v_accvgpr_write_b32 a112, v19
    v_accvgpr_read_b32 v19, a113
    v_mul_f32 v19, v19, v18
    v_accvgpr_write_b32 a113, v19
    v_accvgpr_read_b32 v19, a114
    v_mul_f32 v19, v19, v18
    v_accvgpr_write_b32 a114, v19
    v_accvgpr_read_b32 v19, a115
    v_mul_f32 v19, v19, v18
    v_accvgpr_write_b32 a115, v19
    v_accvgpr_read_b32 v19, a116
    v_mul_f32 v19, v19, v18
    v_accvgpr_write_b32 a116, v19
    v_accvgpr_read_b32 v19, a117
    v_mul_f32 v19, v19, v18
    v_accvgpr_write_b32 a117, v19
    v_accvgpr_read_b32 v19, a118
    v_mul_f32 v19, v19, v18
    v_accvgpr_write_b32 a118, v19
    v_accvgpr_read_b32 v19, a119
    v_mul_f32 v19, v19, v18
    v_accvgpr_write_b32 a119, v19
    v_accvgpr_read_b32 v19, a120
    v_mul_f32 v19, v19, v18
    v_accvgpr_write_b32 a120, v19
    v_accvgpr_read_b32 v19, a121
    v_mul_f32 v19, v19, v18
    v_accvgpr_write_b32 a121, v19
    v_accvgpr_read_b32 v19, a122
    v_mul_f32 v19, v19, v18
    v_accvgpr_write_b32 a122, v19
    v_accvgpr_read_b32 v19, a123
    v_mul_f32 v19, v19, v18
    v_accvgpr_write_b32 a123, v19
    v_accvgpr_read_b32 v19, a124
    v_mul_f32 v19, v19, v18
    v_accvgpr_write_b32 a124, v19
    v_accvgpr_read_b32 v19, a125
    v_mul_f32 v19, v19, v18
    v_accvgpr_write_b32 a125, v19
    v_accvgpr_read_b32 v19, a126
    v_mul_f32 v19, v19, v18
    v_accvgpr_write_b32 a126, v19
    v_accvgpr_read_b32 v19, a127
    v_mul_f32 v19, v19, v18
    v_accvgpr_write_b32 a127, v19
    s_nop 1
    v_mfma_f32_16x16x32_bf16 a[0:3], v[128:131], v[64:67], a[0:3]
    v_mfma_f32_16x16x32_bf16 a[32:35], v[128:131], v[68:71], a[32:35]
    v_mfma_f32_16x16x32_bf16 a[4:7], v[132:135], v[64:67], a[4:7]
    v_mfma_f32_16x16x32_bf16 a[36:39], v[132:135], v[68:71], a[36:39]
    v_mfma_f32_16x16x32_bf16 a[8:11], v[136:139], v[64:67], a[8:11]
    v_mfma_f32_16x16x32_bf16 a[40:43], v[136:139], v[68:71], a[40:43]
    v_mfma_f32_16x16x32_bf16 a[12:15], v[140:143], v[64:67], a[12:15]
    v_mfma_f32_16x16x32_bf16 a[44:47], v[140:143], v[68:71], a[44:47]
    v_mfma_f32_16x16x32_bf16 a[16:19], v[144:147], v[64:67], a[16:19]
    v_mfma_f32_16x16x32_bf16 a[48:51], v[144:147], v[68:71], a[48:51]
    v_mfma_f32_16x16x32_bf16 a[20:23], v[148:151], v[64:67], a[20:23]
    v_mfma_f32_16x16x32_bf16 a[52:55], v[148:151], v[68:71], a[52:55]
    v_mfma_f32_16x16x32_bf16 a[24:27], v[152:155], v[64:67], a[24:27]
    v_mfma_f32_16x16x32_bf16 a[56:59], v[152:155], v[68:71], a[56:59]
    v_mfma_f32_16x16x32_bf16 a[28:31], v[156:159], v[64:67], a[28:31]
    v_mfma_f32_16x16x32_bf16 a[60:63], v[156:159], v[68:71], a[60:63]
    v_mfma_f32_16x16x32_bf16 v[96:99], v[88:91], v[64:67], v[96:99]
    v_mfma_f32_16x16x32_bf16 v[100:103], v[88:91], v[68:71], v[100:103]
    v_mfma_f32_16x16x32_bf16 a[64:67], v[128:131], v[72:75], a[64:67]
    v_mfma_f32_16x16x32_bf16 a[96:99], v[128:131], v[76:79], a[96:99]
    v_mfma_f32_16x16x32_bf16 a[68:71], v[132:135], v[72:75], a[68:71]
    v_mfma_f32_16x16x32_bf16 a[100:103], v[132:135], v[76:79], a[100:103]
    v_mfma_f32_16x16x32_bf16 a[72:75], v[136:139], v[72:75], a[72:75]
    v_mfma_f32_16x16x32_bf16 a[104:107], v[136:139], v[76:79], a[104:107]
    v_mfma_f32_16x16x32_bf16 a[76:79], v[140:143], v[72:75], a[76:79]
    v_mfma_f32_16x16x32_bf16 a[108:111], v[140:143], v[76:79], a[108:111]
    v_mfma_f32_16x16x32_bf16 a[80:83], v[144:147], v[72:75], a[80:83]
    v_mfma_f32_16x16x32_bf16 a[112:115], v[144:147], v[76:79], a[112:115]
    v_mfma_f32_16x16x32_bf16 a[84:87], v[148:151], v[72:75], a[84:87]
    v_mfma_f32_16x16x32_bf16 a[116:119], v[148:151], v[76:79], a[116:119]
    v_mfma_f32_16x16x32_bf16 a[88:91], v[152:155], v[72:75], a[88:91]
    v_mfma_f32_16x16x32_bf16 a[120:123], v[152:155], v[76:79], a[120:123]
    v_mfma_f32_16x16x32_bf16 a[92:95], v[156:159], v[72:75], a[92:95]
    v_mfma_f32_16x16x32_bf16 a[124:127], v[156:159], v[76:79], a[124:127]
    v_mfma_f32_16x16x32_bf16 v[104:107], v[88:91], v[72:75], v[104:107]
    v_mfma_f32_16x16x32_bf16 v[108:111], v[88:91], v[76:79], v[108:111]
    s_nop 7
    s_nop 1
    s_add_u32 s52, s52, 16384
    s_cmp_lt_u32 s52, 0x40000
    s_cbranch_scc1 M_slow_loop
    s_lshl_b32 s13, s6, 10
    s_add_u32 s13, s13, 135168
    v_lshlrev_b32 v22, 2, v0
    v_add_u32 v23, s13, v22
    ds_write_b32 v23, v80
    ds_write_b32 v23, v81 offset:256
    ds_write_b32 v23, v82 offset:512
    ds_write_b32 v23, v83 offset:768
    s_waitcnt lgkmcnt(0)
    s_barrier
    v_add_u32 v23, 135168, v22
    ds_read_b32 v16, v23 offset:0
    ds_read_b32 v17, v23 offset:1024
    ds_read_b32 v18, v23 offset:2048
    ds_read_b32 v19, v23 offset:3072
    s_waitcnt lgkmcnt(0)
    v_max3_f32 v16, v16, v17, v18
    v_max_f32 v16, v16, v19
    v_sub_f32 v16, v80, v16
    v_exp_f32 v16, v16
    s_nop 0
    v_mul_f32 v96, v96, v16
    v_mul_f32 v97, v97, v16
    v_mul_f32 v98, v98, v16
    v_mul_f32 v99, v99, v16
    v_accvgpr_read_b32 v17, a0
    v_mul_f32 v17, v17, v16
    v_accvgpr_write_b32 a0, v17
    v_accvgpr_read_b32 v17, a1
    v_mul_f32 v17, v17, v16
    v_accvgpr_write_b32 a1, v17
    v_accvgpr_read_b32 v17, a2
    v_mul_f32 v17, v17, v16
    v_accvgpr_write_b32 a2, v17
    v_accvgpr_read_b32 v17, a3
    v_mul_f32 v17, v17, v16
    v_accvgpr_write_b32 a3, v17
    v_accvgpr_read_b32 v17, a4
    v_mul_f32 v17, v17, v16
    v_accvgpr_write_b32 a4, v17
    v_accvgpr_read_b32 v17, a5
    v_mul_f32 v17, v17, v16
    v_accvgpr_write_b32 a5, v17
    v_accvgpr_read_b32 v17, a6
    v_mul_f32 v17, v17, v16
    v_accvgpr_write_b32 a6, v17
    v_accvgpr_read_b32 v17, a7
    v_mul_f32 v17, v17, v16
    v_accvgpr_write_b32 a7, v17
    v_accvgpr_read_b32 v17, a8
    v_mul_f32 v17, v17, v16
    v_accvgpr_write_b32 a8, v17
    v_accvgpr_read_b32 v17, a9
    v_mul_f32 v17, v17, v16
    v_accvgpr_write_b32 a9, v17
    v_accvgpr_read_b32 v17, a10
    v_mul_f32 v17, v17, v16
    v_accvgpr_write_b32 a10, v17
    v_accvgpr_read_b32 v17, a11
    v_mul_f32 v17, v17, v16
    v_accvgpr_write_b32 a11, v17
    v_accvgpr_read_b32 v17, a12
    v_mul_f32 v17, v17, v16
    v_accvgpr_write_b32 a12, v17
    v_accvgpr_read_b32 v17, a13
    v_mul_f32 v17, v17, v16
    v_accvgpr_write_b32 a13, v17
    v_accvgpr_read_b32 v17, a14
    v_mul_f32 v17, v17, v16
    v_accvgpr_write_b32 a14, v17
    v_accvgpr_read_b32 v17, a15
    v_mul_f32 v17, v17, v16
    v_accvgpr_write_b32 a15, v17
    v_accvgpr_read_b32 v17, a16
    v_mul_f32 v17, v17, v16
    v_accvgpr_write_b32 a16, v17
    v_accvgpr_read_b32 v17, a17
    v_mul_f32 v17, v17, v16
    v_accvgpr_write_b32 a17, v17
    v_accvgpr_read_b32 v17, a18
    v_mul_f32 v17, v17, v16
    v_accvgpr_write_b32 a18, v17
    v_accvgpr_read_b32 v17, a19
    v_mul_f32 v17, v17, v16
    v_accvgpr_write_b32 a19, v17
    v_accvgpr_read_b32 v17, a20
    v_mul_f32 v17, v17, v16
    v_accvgpr_write_b32 a20, v17
    v_accvgpr_read_b32 v17, a21
    v_mul_f32 v17, v17, v16
    v_accvgpr_write_b32 a21, v17
    v_accvgpr_read_b32 v17, a22
    v_mul_f32 v17, v17, v16
    v_accvgpr_write_b32 a22, v17
    v_accvgpr_read_b32 v17, a23
    v_mul_f32 v17, v17, v16
    v_accvgpr_write_b32 a23, v17
    v_accvgpr_read_b32 v17, a24
    v_mul_f32 v17, v17, v16
    v_accvgpr_write_b32 a24, v17
    v_accvgpr_read_b32 v17, a25
    v_mul_f32 v17, v17, v16
    v_accvgpr_write_b32 a25, v17
    v_accvgpr_read_b32 v17, a26
    v_mul_f32 v17, v17, v16
    v_accvgpr_write_b32 a26, v17
    v_accvgpr_read_b32 v17, a27
    v_mul_f32 v17, v17, v16
    v_accvgpr_write_b32 a27, v17
    v_accvgpr_read_b32 v17, a28
    v_mul_f32 v17, v17, v16
    v_accvgpr_write_b32 a28, v17
    v_accvgpr_read_b32 v17, a29
    v_mul_f32 v17, v17, v16
    v_accvgpr_write_b32 a29, v17
    v_accvgpr_read_b32 v17, a30
    v_mul_f32 v17, v17, v16
    v_accvgpr_write_b32 a30, v17
    v_accvgpr_read_b32 v17, a31
    v_mul_f32 v17, v17, v16
    v_accvgpr_write_b32 a31, v17
    ds_read_b32 v16, v23 offset:256
    ds_read_b32 v17, v23 offset:1280
    ds_read_b32 v18, v23 offset:2304
    ds_read_b32 v19, v23 offset:3328
    s_waitcnt lgkmcnt(0)
    v_max3_f32 v16, v16, v17, v18
    v_max_f32 v16, v16, v19
    v_sub_f32 v16, v81, v16
    v_exp_f32 v16, v16
    s_nop 0
    v_mul_f32 v100, v100, v16
    v_mul_f32 v101, v101, v16
    v_mul_f32 v102, v102, v16
    v_mul_f32 v103, v103, v16
    v_accvgpr_read_b32 v17, a32
    v_mul_f32 v17, v17, v16
    v_accvgpr_write_b32 a32, v17
    v_accvgpr_read_b32 v17, a33
    v_mul_f32 v17, v17, v16
    v_accvgpr_write_b32 a33, v17
    v_accvgpr_read_b32 v17, a34
    v_mul_f32 v17, v17, v16
    v_accvgpr_write_b32 a34, v17
    v_accvgpr_read_b32 v17, a35
    v_mul_f32 v17, v17, v16
    v_accvgpr_write_b32 a35, v17
    v_accvgpr_read_b32 v17, a36
    v_mul_f32 v17, v17, v16
    v_accvgpr_write_b32 a36, v17
    v_accvgpr_read_b32 v17, a37
    v_mul_f32 v17, v17, v16
    v_accvgpr_write_b32 a37, v17
    v_accvgpr_read_b32 v17, a38
    v_mul_f32 v17, v17, v16
    v_accvgpr_write_b32 a38, v17
    v_accvgpr_read_b32 v17, a39
    v_mul_f32 v17, v17, v16
    v_accvgpr_write_b32 a39, v17
    v_accvgpr_read_b32 v17, a40
    v_mul_f32 v17, v17, v16
    v_accvgpr_write_b32 a40, v17
    v_accvgpr_read_b32 v17, a41
    v_mul_f32 v17, v17, v16
    v_accvgpr_write_b32 a41, v17
    v_accvgpr_read_b32 v17, a42
    v_mul_f32 v17, v17, v16
    v_accvgpr_write_b32 a42, v17
    v_accvgpr_read_b32 v17, a43
    v_mul_f32 v17, v17, v16
    v_accvgpr_write_b32 a43, v17
    v_accvgpr_read_b32 v17, a44
    v_mul_f32 v17, v17, v16
    v_accvgpr_write_b32 a44, v17
    v_accvgpr_read_b32 v17, a45
    v_mul_f32 v17, v17, v16
    v_accvgpr_write_b32 a45, v17
    v_accvgpr_read_b32 v17, a46
    v_mul_f32 v17, v17, v16
    v_accvgpr_write_b32 a46, v17
    v_accvgpr_read_b32 v17, a47
    v_mul_f32 v17, v17, v16
    v_accvgpr_write_b32 a47, v17
    v_accvgpr_read_b32 v17, a48
    v_mul_f32 v17, v17, v16
    v_accvgpr_write_b32 a48, v17
    v_accvgpr_read_b32 v17, a49
    v_mul_f32 v17, v17, v16
    v_accvgpr_write_b32 a49, v17
    v_accvgpr_read_b32 v17, a50
    v_mul_f32 v17, v17, v16
    v_accvgpr_write_b32 a50, v17
    v_accvgpr_read_b32 v17, a51
    v_mul_f32 v17, v17, v16
    v_accvgpr_write_b32 a51, v17
    v_accvgpr_read_b32 v17, a52
    v_mul_f32 v17, v17, v16
    v_accvgpr_write_b32 a52, v17
    v_accvgpr_read_b32 v17, a53
    v_mul_f32 v17, v17, v16
    v_accvgpr_write_b32 a53, v17
    v_accvgpr_read_b32 v17, a54
    v_mul_f32 v17, v17, v16
    v_accvgpr_write_b32 a54, v17
    v_accvgpr_read_b32 v17, a55
    v_mul_f32 v17, v17, v16
    v_accvgpr_write_b32 a55, v17
    v_accvgpr_read_b32 v17, a56
    v_mul_f32 v17, v17, v16
    v_accvgpr_write_b32 a56, v17
    v_accvgpr_read_b32 v17, a57
    v_mul_f32 v17, v17, v16
    v_accvgpr_write_b32 a57, v17
    v_accvgpr_read_b32 v17, a58
    v_mul_f32 v17, v17, v16
    v_accvgpr_write_b32 a58, v17
    v_accvgpr_read_b32 v17, a59
    v_mul_f32 v17, v17, v16
    v_accvgpr_write_b32 a59, v17
    v_accvgpr_read_b32 v17, a60
    v_mul_f32 v17, v17, v16
    v_accvgpr_write_b32 a60, v17
    v_accvgpr_read_b32 v17, a61
    v_mul_f32 v17, v17, v16
    v_accvgpr_write_b32 a61, v17
    v_accvgpr_read_b32 v17, a62
    v_mul_f32 v17, v17, v16
    v_accvgpr_write_b32 a62, v17
    v_accvgpr_read_b32 v17, a63
    v_mul_f32 v17, v17, v16
    v_accvgpr_write_b32 a63, v17
    ds_read_b32 v16, v23 offset:512
    ds_read_b32 v17, v23 offset:1536
    ds_read_b32 v18, v23 offset:2560
    ds_read_b32 v19, v23 offset:3584
    s_waitcnt lgkmcnt(0)
    v_max3_f32 v16, v16, v17, v18
    v_max_f32 v16, v16, v19
    v_sub_f32 v16, v82, v16
    v_exp_f32 v16, v16
    s_nop 0
    v_mul_f32 v104, v104, v16
    v_mul_f32 v105, v105, v16
    v_mul_f32 v106, v106, v16
    v_mul_f32 v107, v107, v16
    v_accvgpr_read_b32 v17, a64
    v_mul_f32 v17, v17, v16
    v_accvgpr_write_b32 a64, v17
    v_accvgpr_read_b32 v17, a65
    v_mul_f32 v17, v17, v16
    v_accvgpr_write_b32 a65, v17
    v_accvgpr_read_b32 v17, a66
    v_mul_f32 v17, v17, v16
    v_accvgpr_write_b32 a66, v17
    v_accvgpr_read_b32 v17, a67
    v_mul_f32 v17, v17, v16
    v_accvgpr_write_b32 a67, v17
    v_accvgpr_read_b32 v17, a68
    v_mul_f32 v17, v17, v16
    v_accvgpr_write_b32 a68, v17
    v_accvgpr_read_b32 v17, a69
    v_mul_f32 v17, v17, v16
    v_accvgpr_write_b32 a69, v17
    v_accvgpr_read_b32 v17, a70
    v_mul_f32 v17, v17, v16
    v_accvgpr_write_b32 a70, v17
    v_accvgpr_read_b32 v17, a71
    v_mul_f32 v17, v17, v16
    v_accvgpr_write_b32 a71, v17
    v_accvgpr_read_b32 v17, a72
    v_mul_f32 v17, v17, v16
    v_accvgpr_write_b32 a72, v17
    v_accvgpr_read_b32 v17, a73
    v_mul_f32 v17, v17, v16
    v_accvgpr_write_b32 a73, v17
    v_accvgpr_read_b32 v17, a74
    v_mul_f32 v17, v17, v16
    v_accvgpr_write_b32 a74, v17
    v_accvgpr_read_b32 v17, a75
    v_mul_f32 v17, v17, v16
    v_accvgpr_write_b32 a75, v17
    v_accvgpr_read_b32 v17, a76
    v_mul_f32 v17, v17, v16
    v_accvgpr_write_b32 a76, v17
    v_accvgpr_read_b32 v17, a77
    v_mul_f32 v17, v17, v16
    v_accvgpr_write_b32 a77, v17
    v_accvgpr_read_b32 v17, a78
    v_mul_f32 v17, v17, v16
    v_accvgpr_write_b32 a78, v17
    v_accvgpr_read_b32 v17, a79
    v_mul_f32 v17, v17, v16
    v_accvgpr_write_b32 a79, v17
    v_accvgpr_read_b32 v17, a80
    v_mul_f32 v17, v17, v16
    v_accvgpr_write_b32 a80, v17
    v_accvgpr_read_b32 v17, a81
    v_mul_f32 v17, v17, v16
    v_accvgpr_write_b32 a81, v17
    v_accvgpr_read_b32 v17, a82
    v_mul_f32 v17, v17, v16
    v_accvgpr_write_b32 a82, v17
    v_accvgpr_read_b32 v17, a83
    v_mul_f32 v17, v17, v16
    v_accvgpr_write_b32 a83, v17
    v_accvgpr_read_b32 v17, a84
    v_mul_f32 v17, v17, v16
    v_accvgpr_write_b32 a84, v17
    v_accvgpr_read_b32 v17, a85
    v_mul_f32 v17, v17, v16
    v_accvgpr_write_b32 a85, v17
    v_accvgpr_read_b32 v17, a86
    v_mul_f32 v17, v17, v16
    v_accvgpr_write_b32 a86, v17
    v_accvgpr_read_b32 v17, a87
    v_mul_f32 v17, v17, v16
    v_accvgpr_write_b32 a87, v17
    v_accvgpr_read_b32 v17, a88
    v_mul_f32 v17, v17, v16
    v_accvgpr_write_b32 a88, v17
    v_accvgpr_read_b32 v17, a89
    v_mul_f32 v17, v17, v16
    v_accvgpr_write_b32 a89, v17
    v_accvgpr_read_b32 v17, a90
    v_mul_f32 v17, v17, v16
    v_accvgpr_write_b32 a90, v17
    v_accvgpr_read_b32 v17, a91
    v_mul_f32 v17, v17, v16
    v_accvgpr_write_b32 a91, v17
    v_accvgpr_read_b32 v17, a92
    v_mul_f32 v17, v17, v16
    v_accvgpr_write_b32 a92, v17
    v_accvgpr_read_b32 v17, a93
    v_mul_f32 v17, v17, v16
    v_accvgpr_write_b32 a93, v17
    v_accvgpr_read_b32 v17, a94
    v_mul_f32 v17, v17, v16
    v_accvgpr_write_b32 a94, v17
    v_accvgpr_read_b32 v17, a95
    v_mul_f32 v17, v17, v16
    v_accvgpr_write_b32 a95, v17
    ds_read_b32 v16, v23 offset:768
    ds_read_b32 v17, v23 offset:1792
    ds_read_b32 v18, v23 offset:2816
    ds_read_b32 v19, v23 offset:3840
    s_waitcnt lgkmcnt(0)
    v_max3_f32 v16, v16, v17, v18
    v_max_f32 v16, v16, v19
    v_sub_f32 v16, v83, v16
    v_exp_f32 v16, v16
    s_nop 0
    v_mul_f32 v108, v108, v16
    v_mul_f32 v109, v109, v16
    v_mul_f32 v110, v110, v16
    v_mul_f32 v111, v111, v16
    v_accvgpr_read_b32 v17, a96
    v_mul_f32 v17, v17, v16
    v_accvgpr_write_b32 a96, v17
    v_accvgpr_read_b32 v17, a97
    v_mul_f32 v17, v17, v16
    v_accvgpr_write_b32 a97, v17
    v_accvgpr_read_b32 v17, a98
    v_mul_f32 v17, v17, v16
    v_accvgpr_write_b32 a98, v17
    v_accvgpr_read_b32 v17, a99
    v_mul_f32 v17, v17, v16
    v_accvgpr_write_b32 a99, v17
    v_accvgpr_read_b32 v17, a100
    v_mul_f32 v17, v17, v16
    v_accvgpr_write_b32 a100, v17
    v_accvgpr_read_b32 v17, a101
    v_mul_f32 v17, v17, v16
    v_accvgpr_write_b32 a101, v17
    v_accvgpr_read_b32 v17, a102
    v_mul_f32 v17, v17, v16
    v_accvgpr_write_b32 a102, v17
    v_accvgpr_read_b32 v17, a103
    v_mul_f32 v17, v17, v16
    v_accvgpr_write_b32 a103, v17
    v_accvgpr_read_b32 v17, a104
    v_mul_f32 v17, v17, v16
    v_accvgpr_write_b32 a104, v17
    v_accvgpr_read_b32 v17, a105
    v_mul_f32 v17, v17, v16
    v_accvgpr_write_b32 a105, v17
    v_accvgpr_read_b32 v17, a106
    v_mul_f32 v17, v17, v16
    v_accvgpr_write_b32 a106, v17
    v_accvgpr_read_b32 v17, a107
    v_mul_f32 v17, v17, v16
    v_accvgpr_write_b32 a107, v17
    v_accvgpr_read_b32 v17, a108
    v_mul_f32 v17, v17, v16
    v_accvgpr_write_b32 a108, v17
    v_accvgpr_read_b32 v17, a109
    v_mul_f32 v17, v17, v16
    v_accvgpr_write_b32 a109, v17
    v_accvgpr_read_b32 v17, a110
    v_mul_f32 v17, v17, v16
    v_accvgpr_write_b32 a110, v17
    v_accvgpr_read_b32 v17, a111
    v_mul_f32 v17, v17, v16
    v_accvgpr_write_b32 a111, v17
    v_accvgpr_read_b32 v17, a112
    v_mul_f32 v17, v17, v16
    v_accvgpr_write_b32 a112, v17
    v_accvgpr_read_b32 v17, a113
    v_mul_f32 v17, v17, v16
    v_accvgpr_write_b32 a113, v17
    v_accvgpr_read_b32 v17, a114
    v_mul_f32 v17, v17, v16
    v_accvgpr_write_b32 a114, v17
    v_accvgpr_read_b32 v17, a115
    v_mul_f32 v17, v17, v16
    v_accvgpr_write_b32 a115, v17
    v_accvgpr_read_b32 v17, a116
    v_mul_f32 v17, v17, v16
    v_accvgpr_write_b32 a116, v17
    v_accvgpr_read_b32 v17, a117
    v_mul_f32 v17, v17, v16
    v_accvgpr_write_b32 a117, v17
    v_accvgpr_read_b32 v17, a118
    v_mul_f32 v17, v17, v16
    v_accvgpr_write_b32 a118, v17
    v_accvgpr_read_b32 v17, a119
    v_mul_f32 v17, v17, v16
    v_accvgpr_write_b32 a119, v17
    v_accvgpr_read_b32 v17, a120
    v_mul_f32 v17, v17, v16
    v_accvgpr_write_b32 a120, v17
    v_accvgpr_read_b32 v17, a121
    v_mul_f32 v17, v17, v16
    v_accvgpr_write_b32 a121, v17
    v_accvgpr_read_b32 v17, a122
    v_mul_f32 v17, v17, v16
    v_accvgpr_write_b32 a122, v17
    v_accvgpr_read_b32 v17, a123
    v_mul_f32 v17, v17, v16
    v_accvgpr_write_b32 a123, v17
    v_accvgpr_read_b32 v17, a124
    v_mul_f32 v17, v17, v16
    v_accvgpr_write_b32 a124, v17
    v_accvgpr_read_b32 v17, a125
    v_mul_f32 v17, v17, v16
    v_accvgpr_write_b32 a125, v17
    v_accvgpr_read_b32 v17, a126
    v_mul_f32 v17, v17, v16
    v_accvgpr_write_b32 a126, v17
    v_accvgpr_read_b32 v17, a127
    v_mul_f32 v17, v17, v16
    v_accvgpr_write_b32 a127, v17
    s_barrier
    s_branch M_epi
M_pend:
    s_mov_b32 s3, 0
    v_mov_b32 v22, s46
    v_mov_b32 v23, s47
    v_mov_b32 v24, s8
    s_mov_b64 exec, 1
    global_store_dwordx2 v24, v[22:23], s[42:43] sc1
    s_mov_b64 exec, -1
    s_branch M_pendret
M_slowpoll:
    s_cmp_eq_u32 s55, 0x11111111
    s_cbranch_scc0 M_sp0
    s_mov_b32 s101, 0x40000
    s_branch M_pollret
M_sp0:
    s_mov_b32 s13, 0
M_slowpoll_l:
    global_load_dwordx2 v[84:85], v30, s[56:57] sc1
    s_waitcnt vmcnt(0)
    v_cmp_eq_u64 vcc, v[84:85], s[46:47]
    s_add_u32 s13, s13, 1
    s_nop 0
    s_lshr_b32 s58, vcc_lo, 1
    s_and_b32 s58, s58, vcc_lo
    s_lshr_b32 s59, s58, 2
    s_and_b32 s58, s58, s59
    s_and_b32 s58, s58, 0x11111111
    s_andn2_b32 s58, s58, s55
    s_cbranch_scc1 M_sp1
    s_cmp_gt_u32 s13, 4000
    s_cbranch_scc0 M_slowpoll_l
    s_andn2_b32 s58, 0x11111111, s55
M_sp1:
    s_ff1_i32_b32 s59, s58
    s_bitset1_b32 s55, s59
    s_add_u32 s59, s59, s1
    s_and_b32 s59, s59, 31
    s_lshl_b32 s101, s59, 13
    s_branch M_pollret
M_end:
    s_endpgm
.p2align 6
M_invtab:
.long 0x3f800000, 0x3f5dafd7, 0x3f3ff911, 0x3f263de0, 0x3f0ff59a, 0x3ef953cf, 0x3ed7e89b, 0x3ebaf81b
.long 0x3ea1e89b, 0x3e8c3504, 0x3e72d423, 0x3e5247ed, 0x3e361887, 0x3e1db040, 0x3e088d77, 0x3dec7fd6
.long 0x3dcccccd, 0x3db15978, 0x3d99940d, 0x3d84fe4d, 0x3d6655c2, 0x3d47763f, 0x3d2cba15, 0x3d159348
.long 0x3d0186e3, 0x3ce054d2, 0x3cc2434f, 0x3ca8398b, 0x3c91ad39, 0x3c7c4d33, 0x3c5a7bf2, 0x3c3d3311
.long 0x3c23d70a, 0x3c0de12d, 0x3bf5b9b0, 0x3bd4ca15, 0x3bb8449c, 0x3b9f91cc, 0x3b8a2e77, 0x3b6f520e
.long 0x3b4f3e38, 0x3b33770f, 0x3b1b690d, 0x3b06946f, 0x3ae91528, 0x3ac9d75c, 0x3aaec98e, 0x3a975c0e
.long 0x3a83126f, 0x3a6301e2, 0x3a44948c, 0x3a2a3b44, 0x3a136a16, 0x39ff4fac, 0x39dd1725, 0x39bf74d7
.long 0x39a5cb60, 0x398f9272, 0x3978a815, 0x395753e4, 0x393a7753, 0x39217916, 0x390bd472, 0x38f22ce2
.section .rodata,"a"
.p2align 6
.amdhsa_kernel standalone__kv_cache_quant_pre_rope_vs_post_rope__prompt_kernel
  .amdhsa_next_free_vgpr 512
  .amdhsa_next_free_sgpr 102
  .amdhsa_accum_offset 256
  .amdhsa_group_segment_fixed_size 0
  .amdhsa_kernarg_size 112
  .amdhsa_user_sgpr_count 2
  .amdhsa_user_sgpr_kernarg_segment_ptr 1
  .amdhsa_system_sgpr_workgroup_id_x 1
.end_amdhsa_kernel
.text
```
